```python
import torch

def _softmax(x, axis=-1):
    return torch.softmax(x, dim=axis)
def _gelu(x):
    return torch.nn.functional.gelu(x, approximate="tanh")
def _silu(x):
    return torch.nn.functional.silu(x)
def _sigmoid(x):
    return torch.sigmoid(x)
def _layernorm(x, axis=-1, eps=1e-5):
    m = x.mean(dim=axis, keepdim=True)
    v = x.var(dim=axis, keepdim=True, unbiased=False)
    return (x - m) / torch.sqrt(v + eps)
def _scatter_add(tgt, idx, src, axis=0):
    return tgt.clone().index_add_(axis, idx, src)
def _segment_sum(src, seg, n):
    out = torch.zeros((n,) + src.shape[1:], dtype=src.dtype)
    return out.index_add_(0, seg, src)
def _pad(x, pw):
    flat = tuple(v for pair in reversed(pw) for v in pair)
    return torch.nn.functional.pad(x, flat)

kernel_name = 'standalone__se_block__vision'

def setup_inputs():

    _w = (lambda a: (lambda t: t.to(torch.bfloat16) if t.is_floating_point() else t)(torch.as_tensor(a)))
    H = W = 512
    C = 192; r = max(C // 16, 4)
    return {
        "x": _w((lambda *s: torch.randn(*s, dtype=torch.bfloat16) * 3.2)(1, H, W, C)),
        "w_down": _w((lambda *s: torch.randn(*s, dtype=torch.bfloat16) * 3.2)(C, r)),
        "w_up": _w((lambda *s: torch.randn(*s, dtype=torch.bfloat16) * 3.2)(r, C)),
    }

def reference(x, w_down, w_up):
    s = x.mean(axis=(1, 2))
    s = _sigmoid(_silu(s @ w_down) @ w_up)
    return x * s[:, None, None, :]
```

```asm
; @launch grid=(256,1,1) block=(768,1,1) lds=4368
.amdgcn_target "amdgcn-amd-amdhsa--gfx950"
.text
.globl standalone__se_block__vision_kernel
.p2align 8
.type standalone__se_block__vision_kernel,@function
standalone__se_block__vision_kernel:
    s_cmp_ge_u32 s2, 256
    s_cbranch_scc1 L_end
    s_load_dwordx2 s[4:5], s[0:1], 0
    s_load_dwordx2 s[8:9], s[0:1], 24
    s_load_dwordx2 s[16:17], s[0:1], 32
    s_load_dwordx2 s[12:13], s[0:1], 40
    s_load_dwordx2 s[20:21], s[0:1], 8
    s_load_dwordx2 s[24:25], s[0:1], 16
    v_lshrrev_b32 v38, 6, v0
    v_and_b32 v1, 63, v0
    v_readfirstlane_b32 s28, v38
    v_lshrrev_b32 v38, 3, v1
    v_and_b32 v39, 7, v1
    v_mul_u32_u24 v2, 384, v38
    v_lshl_add_u32 v2, v39, 4, v2
    s_bfe_u32 s47, s2, 0x10002
    s_lshr_b32 s43, s2, 3
    s_and_b32 s46, s2, 3
    s_lshl2_add_u32 s46, s43, s46
    s_mul_i32 s30, s28, 43
    s_lshr_b32 s30, s30, 7
    s_mul_i32 s3, s30, 9
    s_add_u32 s3, s3, s46
    s_and_b32 s3, s3, 127
    s_mul_i32 s50, s3, 49152
    s_mul_i32 s32, s30, 25165440
    s_lshl_b32 s38, s28, 7
    s_add_u32 s32, s32, s38
    s_add_u32 s50, s50, s32
    s_xor_b32 s48, s43, s30
    s_xor_b32 s48, s48, s47
    s_mov_b32 s58, 0xcb765210
    s_bitcmp1_b32 s48, 0
    s_cselect_b32 s58, 0xfeda9843, s58
    s_and_b32 s43, s43, 7
    s_lshl_b32 s43, s43, 2
    s_mov_b32 s54, s58
    s_movk_i32 s49, 3072
    s_bfe_u32 s31, s54, 0x40000
    s_mul_i32 s31, s31, s49
    s_add_u32 s31, s31, s50
    s_mov_b32 s6, 100663296
    s_mov_b32 s7, 0x00020000
    v_mov_b32 v7, 0
    s_mul_i32 s42, s2, 0x80000001
    s_cmp_ge_u32 s42, 48
    s_waitcnt lgkmcnt(0)
    s_cbranch_scc1 L_go
    s_cmp_lg_u32 s28, 0
    s_cbranch_scc1 L_probe_other
    s_lshr_b32 s44, s46, 1
    s_cmp_ge_u32 s44, 6
    s_cselect_b32 s42, 1, 0
    s_cselect_b32 s38, 6, 0
    s_sub_u32 s44, s44, s38
    s_lshr_b32 s58, s44, 1
    s_lshl_b32 s58, s58, 25
    s_lshl_b32 s38, s42, 24
    s_add_u32 s58, s58, s38
    s_add_u32 s58, s58, 0x4000
    s_mul_i32 s59, s2, 3162752
    s_and_b32 s59, s59, 0xefdf00
    s_add_u32 s58, s58, s8
    s_andn2_b32 s58, s58, 0x3fff
    s_add_u32 s58, s58, s59
    s_lshr_b32 s59, s58, 21
    s_xor_b32 s59, s59, s42
    s_and_b32 s59, s59, 1
    s_lshl_b32 s59, s59, 13
    s_or_b32 s58, s58, s59
    s_xor_b32 s59, s58, 0x2000
    s_sub_u32 s58, s58, s8
    s_sub_u32 s59, s59, s8
    s_mov_b32 s10, 100663296
    s_mov_b32 s11, 0x00020000
    s_sub_u32 s38, s8, s4
    s_add_u32 s38, s38, 0x800
    s_lshr_b32 s38, s38, 12
    s_or_b32 s38, s38, s44
    s_mov_b64 exec, 1
    s_bitcmp1_b32 s38, 0
    s_cbranch_scc1 L_probe_out
    buffer_load_dword v38, v7, s[4:7], s58 offen nt
    buffer_load_dword v39, v7, s[4:7], s59 offen nt
    s_branch L_probe_wait
L_probe_out:
    s_mov_b64 exec, 15
    v_lshlrev_b32 v38, 4, v1
    buffer_store_dwordx4 v[0:3], v38, s[8:11], s58 offen sc1
    buffer_store_dwordx4 v[0:3], v38, s[8:11], s59 offen sc1
    s_mov_b64 exec, 1
L_probe_wait:
    s_barrier
    s_mov_b32 s18, 256
    s_mov_b32 s19, 0x00020000
    s_getreg_b32 s35, hwreg(HW_REG_XCC_ID, 0, 3)
    s_sub_u32 s45, s35, s2
    s_and_b32 s45, s45, 7
    s_lshl_b32 s45, s45, 16
    s_or_b32 s45, s45, 0x80000400
    s_lshr_b32 s35, s35, 2
    s_lshl1_add_u32 s44, s44, s42
    s_lshl1_add_u32 s44, s44, s47
    s_lshl_b32 s44, s44, 2
    s_xor_b32 s38, s42, s35
    v_mov_b32 v17, 0
    s_waitcnt vmcnt(1)
    s_memtime s[58:59]
    s_waitcnt vmcnt(0)
    s_memtime s[40:41]
    s_waitcnt lgkmcnt(0)
    s_sub_u32 s58, s40, s58
    s_min_u32 s58, s58, 600
    s_sub_u32 s59, 0, s58
    s_cmp_lg_u32 s38, 0
    s_cselect_b32 s58, s59, s58
    s_add_u32 s58, s58, s45
    v_mov_b32 v16, s58
    buffer_atomic_cmpswap v[16:17], v7, s[16:19], s44 offen
    s_mov_b64 exec, -1
    s_branch L_go
L_probe_other:
    s_barrier
L_go:
L_first:
    buffer_load_dwordx4 v[40:43], v2, s[4:7], s31 offen nt
    s_bfe_u32 s31, s54, 0x40004
    s_mul_i32 s31, s31, s49
    s_add_u32 s31, s31, s50
    buffer_load_dwordx4 v[44:47], v2, s[4:7], s31 offen nt
    s_bfe_u32 s31, s54, 0x40008
    s_mul_i32 s31, s31, s49
    s_add_u32 s31, s31, s50
    buffer_load_dwordx4 v[48:51], v2, s[4:7], s31 offen nt
    s_bfe_u32 s31, s54, 0x4000c
    s_mul_i32 s31, s31, s49
    s_add_u32 s31, s31, s50
    buffer_load_dwordx4 v[52:55], v2, s[4:7], s31 offen nt
    s_bfe_u32 s31, s54, 0x40010
    s_mul_i32 s31, s31, s49
    s_add_u32 s31, s31, s50
    s_mov_b32 s10, 100663296
    s_mov_b32 s11, 0x00020000
    s_mov_b32 s18, 256
    s_mov_b32 s19, 0x00020000
    s_mov_b32 s14, 32768
    s_mov_b32 s15, 0x00020000
    s_mov_b32 s22, 4608
    s_mov_b32 s23, 0x00020000
    s_mov_b32 s26, 4608
    s_mov_b32 s27, 0x00020000
    s_mul_i32 s38, s30, 3
    s_sub_u32 s29, s28, s38
    v_lshrrev_b32 v38, 2, v1
    v_and_b32 v39, 3, v1
    v_lshlrev_b32 v38, 7, v38
    v_lshl_add_u32 v0, v39, 4, v38
    ds_write_b32 v7, v7 offset:4352
    ds_write_b32 v7, v7 offset:4356
    s_xor_b32 s38, s2, 48
    s_xor_b32 s58, s28, 1
    s_or_b32 s38, s38, s58
    s_waitcnt lgkmcnt(0)
    s_barrier
    s_cbranch_scc0 L_clear
    s_branch L_noflagset
L_cleared:
    v_mov_b32 v39, 1
    s_waitcnt vmcnt(0)
    s_mov_b64 exec, 1
    buffer_store_dword v39, v7, s[16:19], 0 offen offset:192 sc1
    s_mov_b64 exec, -1
L_noflagset:
    buffer_load_dwordx4 v[56:59], v2, s[4:7], s31 offen nt
    s_bfe_u32 s31, s54, 0x40014
    s_mul_i32 s31, s31, s49
    s_add_u32 s31, s31, s50
    buffer_load_dwordx4 v[60:63], v2, s[4:7], s31 offen nt
    s_bfe_u32 s31, s54, 0x40018
    s_mul_i32 s31, s31, s49
    s_add_u32 s31, s31, s50
    buffer_load_dwordx4 v[64:67], v2, s[4:7], s31 offen nt
    s_bfe_u32 s31, s54, 0x4001c
    s_mul_i32 s31, s31, s49
    s_add_u32 s31, s31, s50
    buffer_load_dwordx4 v[68:71], v2, s[4:7], s31 offen nt
    s_mov_b32 s34, 1048576
    s_add_u32 s38, s8, 0x800
    s_sub_u32 s39, s38, s4
    s_mov_b32 s36, 0xcb765210
    s_mov_b32 s37, 0xfeda9843
    s_bitcmp1_b32 s38, 12
    s_cselect_b32 s36, 0xfba96540, s36
    s_cselect_b32 s37, 0xedc87321, s37
    s_mov_b32 s35, 0
    s_cmp_lt_u32 s30, 2
    s_cbranch_scc1 L_dec_okA
L_decA:
    ds_read_b32 v6, v7 offset:4356
    s_waitcnt lgkmcnt(0)
    v_readfirstlane_b32 s35, v6
    s_nop 3
    s_cmp_lt_i32 s35, 0
    s_cbranch_scc1 L_dec_okA
    s_sleep 1
    s_sub_u32 s34, s34, 1
    s_cbranch_scc0 L_decA
L_dec_okA:
    s_add_u32 s58, s3, 33
    s_and_b32 s58, s58, 127
    s_mul_i32 s58, s58, 49152
    s_add_u32 s58, s58, 6291456
    s_add_u32 s51, s32, s58
    s_add_u32 s58, s51, 24576
    s_lshr_b32 s59, s58, 25
    s_add_u32 s58, s58, s8
    s_lshr_b32 s58, s58, 21
    s_lshl_b32 s59, s59, 3
    s_lshr_b32 s59, s35, s59
    s_lshr_b32 s38, s59, 1
    s_xor_b32 s58, s58, s38
    s_bitcmp1_b32 s58, 0
    s_cselect_b32 s58, s37, s36
    s_mov_b32 s38, 0xcb765210
    s_bitcmp0_b32 s48, 0
    s_cselect_b32 s38, 0xfeda9843, s38
    s_bitcmp1_b32 s59, 0
    s_cselect_b32 s55, s58, s38
    s_bfe_u32 s31, s55, 0x40000
    s_mul_i32 s31, s31, s49
    s_add_u32 s31, s31, s51
    buffer_load_dwordx4 v[72:75], v2, s[4:7], s31 offen nt
    s_bfe_u32 s31, s55, 0x40004
    s_mul_i32 s31, s31, s49
    s_add_u32 s31, s31, s51
    buffer_load_dwordx4 v[76:79], v2, s[4:7], s31 offen nt
    s_bfe_u32 s31, s55, 0x40008
    s_mul_i32 s31, s31, s49
    s_add_u32 s31, s31, s51
    buffer_load_dwordx4 v[80:83], v2, s[4:7], s31 offen nt
    s_bfe_u32 s31, s55, 0x4000c
    s_mul_i32 s31, s31, s49
    s_add_u32 s31, s31, s51
    buffer_load_dwordx4 v[84:87], v2, s[4:7], s31 offen nt
    s_bfe_u32 s31, s55, 0x40010
    s_mul_i32 s31, s31, s49
    s_add_u32 s31, s31, s51
    buffer_load_dwordx4 v[88:91], v2, s[4:7], s31 offen nt
    s_bfe_u32 s31, s55, 0x40014
    s_mul_i32 s31, s31, s49
    s_add_u32 s31, s31, s51
    buffer_load_dwordx4 v[92:95], v2, s[4:7], s31 offen nt
    s_bfe_u32 s31, s55, 0x40018
    s_mul_i32 s31, s31, s49
    s_add_u32 s31, s31, s51
    buffer_load_dwordx4 v[96:99], v2, s[4:7], s31 offen nt
    s_bfe_u32 s31, s55, 0x4001c
    s_mul_i32 s31, s31, s49
    s_add_u32 s31, s31, s51
    buffer_load_dwordx4 v[100:103], v2, s[4:7], s31 offen nt
    v_lshrrev_b32 v38, 3, v1
    v_and_b32 v39, 7, v1
    v_lshl_add_u32 v38, v39, 3, v38
    v_mul_u32_u24 v38, 24, v38
    s_mul_i32 s38, s29, 1536
    buffer_load_dwordx4 v[26:29], v38, s[20:23], s38 offen
    buffer_load_dwordx2 v[30:31], v38, s[20:23], s38 offen offset:16
    v_lshrrev_b32 v38, 5, v1
    v_and_b32 v39, 31, v1
    v_mul_u32_u24 v38, 384, v38
    v_lshl_add_u32 v38, v39, 2, v38
    s_lshl_b32 s38, s29, 7
    buffer_load_dword v32, v38, s[24:27], s38 offen offset:0
    buffer_load_dword v33, v38, s[24:27], s38 offen offset:768
    buffer_load_dword v34, v38, s[24:27], s38 offen offset:1536
    buffer_load_dword v35, v38, s[24:27], s38 offen offset:2304
    buffer_load_dword v36, v38, s[24:27], s38 offen offset:3072
    buffer_load_dword v37, v38, s[24:27], s38 offen offset:3840
    s_cmp_ge_u32 s30, 2
    s_cbranch_scc1 L_dec_okB
    s_cmp_lg_u32 s28, 2
    s_cbranch_scc1 L_decB
    s_movk_i32 s58, 180
    s_bitcmp1_b32 s39, 12
    s_movk_i32 s59, 120
    s_cselect_b32 s59, s58, s59
    v_mov_b32 v6, s59
    s_mov_b64 exec, 0xf0f0f0
    v_mov_b32 v6, s58
    s_mov_b64 exec, 0xffffff
    v_lshlrev_b32 v38, 2, v1
    buffer_load_dword v16, v38, s[16:19], 0 offen sc1
    s_waitcnt vmcnt(21)
    buffer_load_dword v17, v38, s[16:19], 0 offen sc1
    s_waitcnt vmcnt(18)
    buffer_load_dword v18, v38, s[16:19], 0 offen sc1
    s_waitcnt vmcnt(15)
    buffer_load_dword v19, v38, s[16:19], 0 offen sc1
    s_waitcnt vmcnt(3)
    v_cmp_le_i32 vcc, 0, v16
    s_cbranch_vccz L_have
    s_waitcnt vmcnt(2)
    v_cmp_le_i32 vcc, 0, v17
    v_mov_b32 v16, v17
    s_cbranch_vccz L_have
    s_waitcnt vmcnt(1)
    v_cmp_le_i32 vcc, 0, v18
    v_mov_b32 v16, v18
    s_cbranch_vccz L_have
    s_waitcnt vmcnt(0)
    v_cmp_le_i32 vcc, 0, v19
    v_mov_b32 v16, v19
    s_cbranch_vccz L_have
L_again:
    buffer_load_dword v16, v38, s[16:19], 0 offen sc1
    s_waitcnt vmcnt(0)
    v_cmp_le_i32 vcc, 0, v16
    s_cbranch_vccz L_have
    s_sub_u32 s34, s34, 1
    s_cbranch_scc0 L_again
L_have:
    v_and_b32 v39, 0xfff, v16
    v_lshrrev_b32 v38, 16, v16
    s_nop 0
    v_add_u32_dpp v39, v39, v39 quad_perm:[1,0,3,2] row_mask:0xf bank_mask:0xf
    v_readfirstlane_b32 s59, v38
    s_nop 0
    v_add_u32_dpp v39, v39, v39 quad_perm:[2,3,0,1] row_mask:0xf bank_mask:0xf
    v_subrev_u32 v39, 4096, v39
    v_cmp_gt_i32 vcc, v39, v6
    v_sub_u32 v6, 0, v6
    s_lshr_b32 s58, vcc_lo, 4
    s_and_b32 s38, s58, vcc_lo
    v_cmp_lt_i32 vcc, v39, v6
    s_lshr_b32 s58, vcc_lo, 4
    s_and_b32 s58, s58, vcc_lo
    v_cmp_ne_u32 vcc, s59, v38
    s_and_b32 s38, s38, 0x010101
    s_and_b32 s58, s58, 0x030303
    s_or_b32 s35, s38, s58
    s_cmp_eq_u32 vcc_lo, 0
    s_cselect_b32 s35, s35, 0
    s_add_u32 s59, s59, s2
    s_lshr_b32 s59, s59, 1
    s_add_u32 s58, s8, 0x800
    s_lshr_b32 s58, s58, 12
    s_xor_b32 s59, s59, s58
    s_and_b32 s59, s59, 2
    s_mul_i32 s59, s59, 0x010101
    s_xor_b32 s35, s35, s59
    s_bitset1_b32 s35, 31
    v_mov_b32 v38, s35
    ds_write_b32 v7, v38 offset:4356
    s_mov_b64 exec, -1
    s_branch L_dec_okB
L_decB:
    ds_read_b32 v6, v7 offset:4356
    s_waitcnt lgkmcnt(0)
    v_readfirstlane_b32 s35, v6
    s_nop 3
    s_cmp_lt_i32 s35, 0
    s_cbranch_scc1 L_dec_okB
    s_sleep 1
    s_sub_u32 s34, s34, 1
    s_cbranch_scc0 L_decB
L_dec_okB:
    s_add_u32 s58, s3, 66
    s_and_b32 s58, s58, 127
    s_mul_i32 s58, s58, 49152
    s_add_u32 s58, s58, 12582912
    s_add_u32 s52, s32, s58
    s_add_u32 s58, s52, 24576
    s_lshr_b32 s59, s58, 25
    s_add_u32 s58, s58, s8
    s_lshr_b32 s58, s58, 21
    s_lshl_b32 s59, s59, 3
    s_lshr_b32 s59, s35, s59
    s_lshr_b32 s38, s59, 1
    s_xor_b32 s58, s58, s38
    s_bitcmp1_b32 s58, 0
    s_cselect_b32 s58, s37, s36
    s_mov_b32 s38, 0xcb765210
    s_bitcmp1_b32 s48, 0
    s_cselect_b32 s38, 0xfeda9843, s38
    s_bitcmp1_b32 s59, 0
    s_cselect_b32 s56, s58, s38
    s_bfe_u32 s31, s56, 0x40000
    s_mul_i32 s31, s31, s49
    s_add_u32 s31, s31, s52
    buffer_load_dwordx4 v[104:107], v2, s[4:7], s31 offen nt
    s_bfe_u32 s31, s56, 0x40004
    s_mul_i32 s31, s31, s49
    s_add_u32 s31, s31, s52
    buffer_load_dwordx4 v[108:111], v2, s[4:7], s31 offen nt
    s_bfe_u32 s31, s56, 0x40008
    s_mul_i32 s31, s31, s49
    s_add_u32 s31, s31, s52
    buffer_load_dwordx4 v[112:115], v2, s[4:7], s31 offen nt
    s_bfe_u32 s31, s56, 0x4000c
    s_mul_i32 s31, s31, s49
    s_add_u32 s31, s31, s52
    buffer_load_dwordx4 v[116:119], v2, s[4:7], s31 offen nt
    s_bfe_u32 s31, s56, 0x40010
    s_mul_i32 s31, s31, s49
    s_add_u32 s31, s31, s52
    buffer_load_dwordx4 v[120:123], v2, s[4:7], s31 offen nt
    s_bfe_u32 s31, s56, 0x40014
    s_mul_i32 s31, s31, s49
    s_add_u32 s31, s31, s52
    buffer_load_dwordx4 v[124:127], v2, s[4:7], s31 offen nt
    s_bfe_u32 s31, s56, 0x40018
    s_mul_i32 s31, s31, s49
    s_add_u32 s31, s31, s52
    buffer_load_dwordx4 v[128:131], v2, s[4:7], s31 offen nt
    s_bfe_u32 s31, s56, 0x4001c
    s_mul_i32 s31, s31, s49
    s_add_u32 s31, s31, s52
    buffer_load_dwordx4 v[132:135], v2, s[4:7], s31 offen nt
    s_add_u32 s58, s3, 99
    s_and_b32 s58, s58, 127
    s_mul_i32 s58, s58, 49152
    s_add_u32 s58, s58, 18874368
    s_add_u32 s53, s32, s58
    s_add_u32 s58, s53, 24576
    s_lshr_b32 s59, s58, 25
    s_add_u32 s58, s58, s8
    s_lshr_b32 s58, s58, 21
    s_lshl_b32 s59, s59, 3
    s_lshr_b32 s59, s35, s59
    s_lshr_b32 s38, s59, 1
    s_xor_b32 s58, s58, s38
    s_bitcmp1_b32 s58, 0
    s_cselect_b32 s58, s37, s36
    s_mov_b32 s38, 0xcb765210
    s_bitcmp0_b32 s48, 0
    s_cselect_b32 s38, 0xfeda9843, s38
    s_bitcmp1_b32 s59, 0
    s_cselect_b32 s57, s58, s38
    s_bfe_u32 s31, s57, 0x40000
    s_mul_i32 s31, s31, s49
    s_add_u32 s31, s31, s53
    buffer_load_dwordx4 v[136:139], v2, s[4:7], s31 offen nt
    s_bfe_u32 s31, s57, 0x40004
    s_mul_i32 s31, s31, s49
    s_add_u32 s31, s31, s53
    buffer_load_dwordx4 v[140:143], v2, s[4:7], s31 offen nt
    s_bfe_u32 s31, s57, 0x40008
    s_mul_i32 s31, s31, s49
    s_add_u32 s31, s31, s53
    buffer_load_dwordx4 v[144:147], v2, s[4:7], s31 offen nt
    s_bfe_u32 s31, s57, 0x4000c
    s_mul_i32 s31, s31, s49
    s_add_u32 s31, s31, s53
    buffer_load_dwordx4 v[148:151], v2, s[4:7], s31 offen nt
    s_bfe_u32 s31, s57, 0x40010
    s_mul_i32 s31, s31, s49
    s_add_u32 s31, s31, s53
    buffer_load_dwordx4 v[152:155], v2, s[4:7], s31 offen nt
    s_bfe_u32 s31, s57, 0x40014
    s_mul_i32 s31, s31, s49
    s_add_u32 s31, s31, s53
    buffer_load_dwordx4 v[156:159], v2, s[4:7], s31 offen nt
    s_bfe_u32 s31, s57, 0x40018
    s_mul_i32 s31, s31, s49
    s_add_u32 s31, s31, s53
    buffer_load_dwordx4 v[160:163], v2, s[4:7], s31 offen nt
    s_bfe_u32 s31, s57, 0x4001c
    s_mul_i32 s31, s31, s49
    s_add_u32 s31, s31, s53
    buffer_load_dwordx4 v[164:167], v2, s[4:7], s31 offen nt
    s_cmp_lg_u32 s28, 0
    s_cbranch_scc1 L_noflag
    buffer_load_dword v6, v7, s[16:19], 0 offen offset:192 sc1
L_noflag:
    s_mov_b32 s33, 0xffff0000
    v_lshrrev_b32 v38, 4, v1
    s_lshl_b32 s38, s28, 6
    v_lshl_add_u32 v3, v38, 4, s38
    v_and_b32 v39, 15, v1
    v_lshlrev_b32 v39, 2, v39
    v_lshl_add_u32 v4, v38, 6, v39
    s_mov_b32 s44, 0x00010001
    s_mov_b32 s45, 0x00010001
    s_lshl_b32 s38, s2, 7
    v_lshl_add_u32 v5, v1, 2, s38
    v_cmp_gt_u32 vcc, 16, v1
    v_mov_b32 v38, 0x40000000
    v_mov_b32 v39, 1
    v_cndmask_b32 v5, v38, v5, vcc
    s_waitcnt vmcnt(16)
    v_lshlrev_b32 v8, 16, v40
    v_and_b32 v9, s33, v40
    v_lshlrev_b32 v10, 16, v41
    v_and_b32 v11, s33, v41
    v_lshlrev_b32 v12, 16, v42
    v_and_b32 v13, s33, v42
    v_lshlrev_b32 v14, 16, v43
    v_and_b32 v15, s33, v43
    v_lshlrev_b32 v16, 16, v44
    v_and_b32 v17, s33, v44
    v_lshlrev_b32 v18, 16, v45
    v_and_b32 v19, s33, v45
    v_pk_add_f32 v[8:9], v[8:9], v[16:17]
    v_pk_add_f32 v[10:11], v[10:11], v[18:19]
    v_lshlrev_b32 v16, 16, v46
    v_and_b32 v17, s33, v46
    v_lshlrev_b32 v18, 16, v47
    v_and_b32 v19, s33, v47
    v_pk_add_f32 v[12:13], v[12:13], v[16:17]
    v_pk_add_f32 v[14:15], v[14:15], v[18:19]
    v_lshlrev_b32 v16, 16, v48
    v_and_b32 v17, s33, v48
    v_lshlrev_b32 v18, 16, v49
    v_and_b32 v19, s33, v49
    v_pk_add_f32 v[8:9], v[8:9], v[16:17]
    v_pk_add_f32 v[10:11], v[10:11], v[18:19]
    v_lshlrev_b32 v16, 16, v50
    v_and_b32 v17, s33, v50
    v_lshlrev_b32 v18, 16, v51
    v_and_b32 v19, s33, v51
    v_pk_add_f32 v[12:13], v[12:13], v[16:17]
    v_pk_add_f32 v[14:15], v[14:15], v[18:19]
    v_lshlrev_b32 v16, 16, v52
    v_and_b32 v17, s33, v52
    v_lshlrev_b32 v18, 16, v53
    v_and_b32 v19, s33, v53
    v_pk_add_f32 v[8:9], v[8:9], v[16:17]
    v_pk_add_f32 v[10:11], v[10:11], v[18:19]
    v_lshlrev_b32 v16, 16, v54
    v_and_b32 v17, s33, v54
    v_lshlrev_b32 v18, 16, v55
    v_and_b32 v19, s33, v55
    v_pk_add_f32 v[12:13], v[12:13], v[16:17]
    v_pk_add_f32 v[14:15], v[14:15], v[18:19]
    v_lshlrev_b32 v16, 16, v56
    v_and_b32 v17, s33, v56
    v_lshlrev_b32 v18, 16, v57
    v_and_b32 v19, s33, v57
    v_pk_add_f32 v[8:9], v[8:9], v[16:17]
    v_pk_add_f32 v[10:11], v[10:11], v[18:19]
    v_lshlrev_b32 v16, 16, v58
    v_and_b32 v17, s33, v58
    v_lshlrev_b32 v18, 16, v59
    v_and_b32 v19, s33, v59
    v_pk_add_f32 v[12:13], v[12:13], v[16:17]
    v_pk_add_f32 v[14:15], v[14:15], v[18:19]
    v_lshlrev_b32 v16, 16, v60
    v_and_b32 v17, s33, v60
    v_lshlrev_b32 v18, 16, v61
    v_and_b32 v19, s33, v61
    v_pk_add_f32 v[8:9], v[8:9], v[16:17]
    v_pk_add_f32 v[10:11], v[10:11], v[18:19]
    v_lshlrev_b32 v16, 16, v62
    v_and_b32 v17, s33, v62
    v_lshlrev_b32 v18, 16, v63
    v_and_b32 v19, s33, v63
    v_pk_add_f32 v[12:13], v[12:13], v[16:17]
    v_pk_add_f32 v[14:15], v[14:15], v[18:19]
    v_lshlrev_b32 v16, 16, v64
    v_and_b32 v17, s33, v64
    v_lshlrev_b32 v18, 16, v65
    v_and_b32 v19, s33, v65
    v_pk_add_f32 v[8:9], v[8:9], v[16:17]
    v_pk_add_f32 v[10:11], v[10:11], v[18:19]
    v_lshlrev_b32 v16, 16, v66
    v_and_b32 v17, s33, v66
    v_lshlrev_b32 v18, 16, v67
    v_and_b32 v19, s33, v67
    v_pk_add_f32 v[12:13], v[12:13], v[16:17]
    v_pk_add_f32 v[14:15], v[14:15], v[18:19]
    v_lshlrev_b32 v16, 16, v68
    v_and_b32 v17, s33, v68
    v_lshlrev_b32 v18, 16, v69
    v_and_b32 v19, s33, v69
    v_pk_add_f32 v[8:9], v[8:9], v[16:17]
    v_pk_add_f32 v[10:11], v[10:11], v[18:19]
    v_lshlrev_b32 v16, 16, v70
    v_and_b32 v17, s33, v70
    v_lshlrev_b32 v18, 16, v71
    v_and_b32 v19, s33, v71
    v_pk_add_f32 v[12:13], v[12:13], v[16:17]
    v_pk_add_f32 v[14:15], v[14:15], v[18:19]
    v_lshlrev_b32 v20, 16, v26
    v_and_b32 v21, s33, v26
    v_lshlrev_b32 v22, 16, v27
    v_and_b32 v23, s33, v27
    v_lshlrev_b32 v24, 16, v28
    v_and_b32 v25, s33, v28
    v_lshlrev_b32 v26, 16, v29
    v_and_b32 v27, s33, v29
    v_lshlrev_b32 v28, 16, v30
    v_and_b32 v29, s33, v30
    v_lshlrev_b32 v30, 16, v31
    v_and_b32 v31, s33, v31
    v_lshlrev_b32 v16, 16, v72
    v_and_b32 v17, s33, v72
    v_lshlrev_b32 v18, 16, v73
    v_and_b32 v19, s33, v73
    v_pk_add_f32 v[8:9], v[8:9], v[16:17]
    v_pk_add_f32 v[10:11], v[10:11], v[18:19]
    v_lshlrev_b32 v16, 16, v74
    v_and_b32 v17, s33, v74
    v_lshlrev_b32 v18, 16, v75
    v_and_b32 v19, s33, v75
    v_pk_add_f32 v[12:13], v[12:13], v[16:17]
    v_pk_add_f32 v[14:15], v[14:15], v[18:19]
    v_lshlrev_b32 v16, 16, v76
    v_and_b32 v17, s33, v76
    v_lshlrev_b32 v18, 16, v77
    v_and_b32 v19, s33, v77
    v_pk_add_f32 v[8:9], v[8:9], v[16:17]
    v_pk_add_f32 v[10:11], v[10:11], v[18:19]
    v_lshlrev_b32 v16, 16, v78
    v_and_b32 v17, s33, v78
    v_lshlrev_b32 v18, 16, v79
    v_and_b32 v19, s33, v79
    v_pk_add_f32 v[12:13], v[12:13], v[16:17]
    v_pk_add_f32 v[14:15], v[14:15], v[18:19]
    v_lshlrev_b32 v16, 16, v80
    v_and_b32 v17, s33, v80
    v_lshlrev_b32 v18, 16, v81
    v_and_b32 v19, s33, v81
    v_pk_add_f32 v[8:9], v[8:9], v[16:17]
    v_pk_add_f32 v[10:11], v[10:11], v[18:19]
    v_lshlrev_b32 v16, 16, v82
    v_and_b32 v17, s33, v82
    v_lshlrev_b32 v18, 16, v83
    v_and_b32 v19, s33, v83
    v_pk_add_f32 v[12:13], v[12:13], v[16:17]
    v_pk_add_f32 v[14:15], v[14:15], v[18:19]
    v_lshlrev_b32 v16, 16, v84
    v_and_b32 v17, s33, v84
    v_lshlrev_b32 v18, 16, v85
    v_and_b32 v19, s33, v85
    v_pk_add_f32 v[8:9], v[8:9], v[16:17]
    v_pk_add_f32 v[10:11], v[10:11], v[18:19]
    v_lshlrev_b32 v16, 16, v86
    v_and_b32 v17, s33, v86
    v_lshlrev_b32 v18, 16, v87
    v_and_b32 v19, s33, v87
    v_pk_add_f32 v[12:13], v[12:13], v[16:17]
    v_pk_add_f32 v[14:15], v[14:15], v[18:19]
    v_lshlrev_b32 v16, 16, v88
    v_and_b32 v17, s33, v88
    v_lshlrev_b32 v18, 16, v89
    v_and_b32 v19, s33, v89
    v_pk_add_f32 v[8:9], v[8:9], v[16:17]
    v_pk_add_f32 v[10:11], v[10:11], v[18:19]
    v_lshlrev_b32 v16, 16, v90
    v_and_b32 v17, s33, v90
    v_lshlrev_b32 v18, 16, v91
    v_and_b32 v19, s33, v91
    v_pk_add_f32 v[12:13], v[12:13], v[16:17]
    v_pk_add_f32 v[14:15], v[14:15], v[18:19]
    v_lshlrev_b32 v16, 16, v92
    v_and_b32 v17, s33, v92
    v_lshlrev_b32 v18, 16, v93
    v_and_b32 v19, s33, v93
    v_pk_add_f32 v[8:9], v[8:9], v[16:17]
    v_pk_add_f32 v[10:11], v[10:11], v[18:19]
    v_lshlrev_b32 v16, 16, v94
    v_and_b32 v17, s33, v94
    v_lshlrev_b32 v18, 16, v95
    v_and_b32 v19, s33, v95
    v_pk_add_f32 v[12:13], v[12:13], v[16:17]
    v_pk_add_f32 v[14:15], v[14:15], v[18:19]
    v_lshlrev_b32 v16, 16, v96
    v_and_b32 v17, s33, v96
    v_lshlrev_b32 v18, 16, v97
    v_and_b32 v19, s33, v97
    v_pk_add_f32 v[8:9], v[8:9], v[16:17]
    v_pk_add_f32 v[10:11], v[10:11], v[18:19]
    v_lshlrev_b32 v16, 16, v98
    v_and_b32 v17, s33, v98
    v_lshlrev_b32 v18, 16, v99
    v_and_b32 v19, s33, v99
    v_pk_add_f32 v[12:13], v[12:13], v[16:17]
    v_pk_add_f32 v[14:15], v[14:15], v[18:19]
    v_lshlrev_b32 v16, 16, v100
    v_and_b32 v17, s33, v100
    v_lshlrev_b32 v18, 16, v101
    v_and_b32 v19, s33, v101
    v_pk_add_f32 v[8:9], v[8:9], v[16:17]
    v_pk_add_f32 v[10:11], v[10:11], v[18:19]
    v_lshlrev_b32 v16, 16, v102
    v_and_b32 v17, s33, v102
    v_lshlrev_b32 v18, 16, v103
    v_and_b32 v19, s33, v103
    v_pk_add_f32 v[12:13], v[12:13], v[16:17]
    v_pk_add_f32 v[14:15], v[14:15], v[18:19]
    s_waitcnt vmcnt(15)
    v_lshlrev_b32 v16, 16, v104
    v_and_b32 v17, s33, v104
    v_lshlrev_b32 v18, 16, v105
    v_and_b32 v19, s33, v105
    v_pk_add_f32 v[8:9], v[8:9], v[16:17]
    v_pk_add_f32 v[10:11], v[10:11], v[18:19]
    v_lshlrev_b32 v16, 16, v106
    v_and_b32 v17, s33, v106
    v_lshlrev_b32 v18, 16, v107
    v_and_b32 v19, s33, v107
    v_pk_add_f32 v[12:13], v[12:13], v[16:17]
    v_pk_add_f32 v[14:15], v[14:15], v[18:19]
    s_waitcnt vmcnt(14)
    v_lshlrev_b32 v16, 16, v108
    v_and_b32 v17, s33, v108
    v_lshlrev_b32 v18, 16, v109
    v_and_b32 v19, s33, v109
    v_pk_add_f32 v[8:9], v[8:9], v[16:17]
    v_pk_add_f32 v[10:11], v[10:11], v[18:19]
    v_lshlrev_b32 v16, 16, v110
    v_and_b32 v17, s33, v110
    v_lshlrev_b32 v18, 16, v111
    v_and_b32 v19, s33, v111
    v_pk_add_f32 v[12:13], v[12:13], v[16:17]
    v_pk_add_f32 v[14:15], v[14:15], v[18:19]
    s_waitcnt vmcnt(13)
    v_lshlrev_b32 v16, 16, v112
    v_and_b32 v17, s33, v112
    v_lshlrev_b32 v18, 16, v113
    v_and_b32 v19, s33, v113
    v_pk_add_f32 v[8:9], v[8:9], v[16:17]
    v_pk_add_f32 v[10:11], v[10:11], v[18:19]
    v_lshlrev_b32 v16, 16, v114
    v_and_b32 v17, s33, v114
    v_lshlrev_b32 v18, 16, v115
    v_and_b32 v19, s33, v115
    v_pk_add_f32 v[12:13], v[12:13], v[16:17]
    v_pk_add_f32 v[14:15], v[14:15], v[18:19]
    s_waitcnt vmcnt(12)
    v_lshlrev_b32 v16, 16, v116
    v_and_b32 v17, s33, v116
    v_lshlrev_b32 v18, 16, v117
    v_and_b32 v19, s33, v117
    v_pk_add_f32 v[8:9], v[8:9], v[16:17]
    v_pk_add_f32 v[10:11], v[10:11], v[18:19]
    v_lshlrev_b32 v16, 16, v118
    v_and_b32 v17, s33, v118
    v_lshlrev_b32 v18, 16, v119
    v_and_b32 v19, s33, v119
    v_pk_add_f32 v[12:13], v[12:13], v[16:17]
    v_pk_add_f32 v[14:15], v[14:15], v[18:19]
    s_waitcnt vmcnt(11)
    v_lshlrev_b32 v16, 16, v120
    v_and_b32 v17, s33, v120
    v_lshlrev_b32 v18, 16, v121
    v_and_b32 v19, s33, v121
    v_pk_add_f32 v[8:9], v[8:9], v[16:17]
    v_pk_add_f32 v[10:11], v[10:11], v[18:19]
    v_lshlrev_b32 v16, 16, v122
    v_and_b32 v17, s33, v122
    v_lshlrev_b32 v18, 16, v123
    v_and_b32 v19, s33, v123
    v_pk_add_f32 v[12:13], v[12:13], v[16:17]
    v_pk_add_f32 v[14:15], v[14:15], v[18:19]
    s_waitcnt vmcnt(10)
    v_lshlrev_b32 v16, 16, v124
    v_and_b32 v17, s33, v124
    v_lshlrev_b32 v18, 16, v125
    v_and_b32 v19, s33, v125
    v_pk_add_f32 v[8:9], v[8:9], v[16:17]
    v_pk_add_f32 v[10:11], v[10:11], v[18:19]
    v_lshlrev_b32 v16, 16, v126
    v_and_b32 v17, s33, v126
    v_lshlrev_b32 v18, 16, v127
    v_and_b32 v19, s33, v127
    v_pk_add_f32 v[12:13], v[12:13], v[16:17]
    v_pk_add_f32 v[14:15], v[14:15], v[18:19]
    s_waitcnt vmcnt(9)
    v_lshlrev_b32 v16, 16, v128
    v_and_b32 v17, s33, v128
    v_lshlrev_b32 v18, 16, v129
    v_and_b32 v19, s33, v129
    v_pk_add_f32 v[8:9], v[8:9], v[16:17]
    v_pk_add_f32 v[10:11], v[10:11], v[18:19]
    v_lshlrev_b32 v16, 16, v130
    v_and_b32 v17, s33, v130
    v_lshlrev_b32 v18, 16, v131
    v_and_b32 v19, s33, v131
    v_pk_add_f32 v[12:13], v[12:13], v[16:17]
    v_pk_add_f32 v[14:15], v[14:15], v[18:19]
    s_waitcnt vmcnt(8)
    v_lshlrev_b32 v16, 16, v132
    v_and_b32 v17, s33, v132
    v_lshlrev_b32 v18, 16, v133
    v_and_b32 v19, s33, v133
    v_pk_add_f32 v[8:9], v[8:9], v[16:17]
    v_pk_add_f32 v[10:11], v[10:11], v[18:19]
    v_lshlrev_b32 v16, 16, v134
    v_and_b32 v17, s33, v134
    v_lshlrev_b32 v18, 16, v135
    v_and_b32 v19, s33, v135
    v_pk_add_f32 v[12:13], v[12:13], v[16:17]
    v_pk_add_f32 v[14:15], v[14:15], v[18:19]
    s_waitcnt vmcnt(7)
    v_lshlrev_b32 v16, 16, v136
    v_and_b32 v17, s33, v136
    v_lshlrev_b32 v18, 16, v137
    v_and_b32 v19, s33, v137
    v_pk_add_f32 v[8:9], v[8:9], v[16:17]
    v_pk_add_f32 v[10:11], v[10:11], v[18:19]
    v_lshlrev_b32 v16, 16, v138
    v_and_b32 v17, s33, v138
    v_lshlrev_b32 v18, 16, v139
    v_and_b32 v19, s33, v139
    v_pk_add_f32 v[12:13], v[12:13], v[16:17]
    v_pk_add_f32 v[14:15], v[14:15], v[18:19]
    s_waitcnt vmcnt(6)
    v_lshlrev_b32 v16, 16, v140
    v_and_b32 v17, s33, v140
    v_lshlrev_b32 v18, 16, v141
    v_and_b32 v19, s33, v141
    v_pk_add_f32 v[8:9], v[8:9], v[16:17]
    v_pk_add_f32 v[10:11], v[10:11], v[18:19]
    v_lshlrev_b32 v16, 16, v142
    v_and_b32 v17, s33, v142
    v_lshlrev_b32 v18, 16, v143
    v_and_b32 v19, s33, v143
    v_pk_add_f32 v[12:13], v[12:13], v[16:17]
    v_pk_add_f32 v[14:15], v[14:15], v[18:19]
    s_waitcnt vmcnt(5)
    v_lshlrev_b32 v16, 16, v144
    v_and_b32 v17, s33, v144
    v_lshlrev_b32 v18, 16, v145
    v_and_b32 v19, s33, v145
    v_pk_add_f32 v[8:9], v[8:9], v[16:17]
    v_pk_add_f32 v[10:11], v[10:11], v[18:19]
    v_lshlrev_b32 v16, 16, v146
    v_and_b32 v17, s33, v146
    v_lshlrev_b32 v18, 16, v147
    v_and_b32 v19, s33, v147
    v_pk_add_f32 v[12:13], v[12:13], v[16:17]
    v_pk_add_f32 v[14:15], v[14:15], v[18:19]
    s_waitcnt vmcnt(4)
    v_lshlrev_b32 v16, 16, v148
    v_and_b32 v17, s33, v148
    v_lshlrev_b32 v18, 16, v149
    v_and_b32 v19, s33, v149
    v_pk_add_f32 v[8:9], v[8:9], v[16:17]
    v_pk_add_f32 v[10:11], v[10:11], v[18:19]
    v_lshlrev_b32 v16, 16, v150
    v_and_b32 v17, s33, v150
    v_lshlrev_b32 v18, 16, v151
    v_and_b32 v19, s33, v151
    v_pk_add_f32 v[12:13], v[12:13], v[16:17]
    v_pk_add_f32 v[14:15], v[14:15], v[18:19]
    s_waitcnt vmcnt(3)
    v_lshlrev_b32 v16, 16, v152
    v_and_b32 v17, s33, v152
    v_lshlrev_b32 v18, 16, v153
    v_and_b32 v19, s33, v153
    v_pk_add_f32 v[8:9], v[8:9], v[16:17]
    v_pk_add_f32 v[10:11], v[10:11], v[18:19]
    v_lshlrev_b32 v16, 16, v154
    v_and_b32 v17, s33, v154
    v_lshlrev_b32 v18, 16, v155
    v_and_b32 v19, s33, v155
    v_pk_add_f32 v[12:13], v[12:13], v[16:17]
    v_pk_add_f32 v[14:15], v[14:15], v[18:19]
    s_waitcnt vmcnt(2)
    v_lshlrev_b32 v16, 16, v156
    v_and_b32 v17, s33, v156
    v_lshlrev_b32 v18, 16, v157
    v_and_b32 v19, s33, v157
    v_pk_add_f32 v[8:9], v[8:9], v[16:17]
    v_pk_add_f32 v[10:11], v[10:11], v[18:19]
    v_lshlrev_b32 v16, 16, v158
    v_and_b32 v17, s33, v158
    v_lshlrev_b32 v18, 16, v159
    v_and_b32 v19, s33, v159
    v_pk_add_f32 v[12:13], v[12:13], v[16:17]
    v_pk_add_f32 v[14:15], v[14:15], v[18:19]
    s_waitcnt vmcnt(1)
    v_lshlrev_b32 v16, 16, v160
    v_and_b32 v17, s33, v160
    v_lshlrev_b32 v18, 16, v161
    v_and_b32 v19, s33, v161
    v_pk_add_f32 v[8:9], v[8:9], v[16:17]
    v_pk_add_f32 v[10:11], v[10:11], v[18:19]
    v_lshlrev_b32 v16, 16, v162
    v_and_b32 v17, s33, v162
    v_lshlrev_b32 v18, 16, v163
    v_and_b32 v19, s33, v163
    v_pk_add_f32 v[12:13], v[12:13], v[16:17]
    v_pk_add_f32 v[14:15], v[14:15], v[18:19]
    s_waitcnt vmcnt(0)
    v_lshlrev_b32 v16, 16, v164
    v_and_b32 v17, s33, v164
    v_lshlrev_b32 v18, 16, v165
    v_and_b32 v19, s33, v165
    v_pk_add_f32 v[8:9], v[8:9], v[16:17]
    v_pk_add_f32 v[10:11], v[10:11], v[18:19]
    v_lshlrev_b32 v16, 16, v166
    v_and_b32 v17, s33, v166
    v_lshlrev_b32 v18, 16, v167
    v_and_b32 v19, s33, v167
    v_pk_add_f32 v[12:13], v[12:13], v[16:17]
    v_pk_add_f32 v[14:15], v[14:15], v[18:19]
    s_cmp_lg_u32 s28, 0
    s_cbranch_scc1 L_chk_ok
L_chk:
    v_cmp_eq_u32 vcc, 0, v6
    s_cbranch_vccz L_chk_ok
    s_sleep 4
    buffer_load_dword v6, v7, s[16:19], 0 offen offset:192 sc1
    s_waitcnt vmcnt(0)
    s_sub_u32 s34, s34, 1
    s_cbranch_scc0 L_chk
L_chk_ok:
    v_permlane32_swap_b32 v8, v12
    v_permlane32_swap_b32 v9, v13
    v_permlane32_swap_b32 v10, v14
    v_permlane32_swap_b32 v11, v15
    v_pk_add_f32 v[8:9], v[8:9], v[12:13]
    v_pk_add_f32 v[10:11], v[10:11], v[14:15]
    s_nop 1
    v_permlane16_swap_b32 v8, v10
    v_permlane16_swap_b32 v9, v11
    v_pk_add_f32 v[8:9], v[8:9], v[10:11]
    s_nop 1
    v_add_f32_dpp v10, v8, v8 row_ror:8 row_mask:0xf bank_mask:0x3
    s_nop 1
    v_add_f32_dpp v10, v9, v9 row_ror:8 row_mask:0xf bank_mask:0xc
    v_pk_mul_f32 v[20:21], v[10:11], v[20:21] op_sel_hi:[0,1]
    v_pk_mul_f32 v[26:27], v[10:11], v[26:27] op_sel_hi:[0,1]
    v_pk_mul_f32 v[22:23], v[10:11], v[22:23] op_sel_hi:[0,1]
    v_pk_mul_f32 v[28:29], v[10:11], v[28:29] op_sel_hi:[0,1]
    v_pk_mul_f32 v[24:25], v[10:11], v[24:25] op_sel_hi:[0,1]
    v_pk_mul_f32 v[30:31], v[10:11], v[30:31] op_sel_hi:[0,1]
    v_permlane32_swap_b32 v20, v26
    v_permlane32_swap_b32 v21, v27
    v_permlane32_swap_b32 v22, v28
    v_permlane32_swap_b32 v23, v29
    v_permlane32_swap_b32 v24, v30
    v_permlane32_swap_b32 v25, v31
    v_pk_add_f32 v[20:21], v[20:21], v[26:27]
    v_pk_add_f32 v[22:23], v[22:23], v[28:29]
    v_pk_add_f32 v[24:25], v[24:25], v[30:31]
    s_nop 1
    v_permlane16_swap_b32 v20, v23
    v_permlane16_swap_b32 v21, v24
    v_permlane16_swap_b32 v22, v25
    v_add_f32 v20, v20, v23
    v_add_f32 v21, v21, v24
    v_add_f32 v22, v22, v25
    v_add_f32_dpp v20, v20, v20 row_ror:8 row_mask:0xf bank_mask:0xf
    v_add_f32_dpp v21, v21, v21 row_ror:8 row_mask:0xf bank_mask:0xf
    v_add_f32_dpp v22, v22, v22 row_ror:8 row_mask:0xf bank_mask:0xf
    v_add_f32_dpp v20, v20, v20 row_ror:4 row_mask:0xf bank_mask:0xf
    v_add_f32_dpp v21, v21, v21 row_ror:4 row_mask:0xf bank_mask:0xf
    v_add_f32_dpp v22, v22, v22 row_ror:4 row_mask:0xf bank_mask:0xf
    v_add_f32_dpp v20, v20, v20 row_ror:2 row_mask:0xf bank_mask:0xf
    v_add_f32_dpp v21, v21, v21 row_ror:2 row_mask:0xf bank_mask:0xf
    v_add_f32_dpp v22, v22, v22 row_ror:2 row_mask:0xf bank_mask:0xf
    v_add_f32_dpp v20, v20, v20 row_ror:1 row_mask:0xf bank_mask:0xf
    v_add_f32_dpp v21, v21, v21 row_ror:1 row_mask:0xf bank_mask:0xf
    v_add_f32_dpp v22, v22, v22 row_ror:1 row_mask:0xf bank_mask:0xf
    s_mov_b64 exec, s[44:45]
    ds_write_b128 v3, v[20:23]
    s_mov_b64 exec, 1
    ds_add_rtn_u32 v38, v7, v39 offset:4352
    s_mov_b64 exec, -1
    ds_read_b32 v16, v4
    ds_read_b32 v17, v4 offset:256
    ds_read_b32 v18, v4 offset:512
    s_waitcnt lgkmcnt(0)
    v_readfirstlane_b32 s42, v38
    v_add_f32 v16, v16, v17
    v_add_f32 v16, v16, v18
    v_mov_b32 v17, v16
    s_cmp_lg_u32 s42, 11
    s_cbranch_scc1 L_nopub
    v_permlane32_swap_b32 v16, v17
    v_add_f32 v16, v16, v17
    v_mov_b32 v17, v16
    s_nop 1
    v_permlane16_swap_b32 v16, v17
    v_add_f32 v16, v16, v17
    v_min_u32 v16, -2, v16
    buffer_store_dword v16, v5, s[12:15], 0 offen sc1
L_nopub:
    s_lshl_b32 s40, s28, 12
    s_add_u32 s41, s40, 2048
    v_lshrrev_b32 v38, 4, v1
    v_and_b32 v39, 3, v1
    v_mad_u32_u24 v38, v39, 3, v38
    s_lshl_b32 s38, s28, 2
    s_add_u32 s38, s38, 768
    v_lshl_add_u32 v4, v38, 5, s38
    v_and_b32 v38, 15, v1
    v_min_u32 v38, 5, v38
    v_lshrrev_b32 v39, 5, v1
    v_lshl_add_u32 v38, v38, 1, v39
    v_lshlrev_b32 v5, 5, v38
    v_and_b32 v38, 31, v1
    v_lshl_add_u32 v38, v38, 1, v39
    s_lshl_b32 s38, s28, 8
    s_add_u32 s38, s38, 1280
    v_lshl_add_u32 v7, v38, 2, s38
    v_and_b32 v38, 7, v1
    v_lshl_add_u32 v6, v38, 5, s38
    v_lshlrev_b32 v20, 16, v32
    v_and_b32 v21, s33, v32
    v_lshlrev_b32 v22, 16, v33
    v_and_b32 v23, s33, v33
    v_lshlrev_b32 v24, 16, v34
    v_and_b32 v25, s33, v34
    v_lshlrev_b32 v26, 16, v35
    v_and_b32 v27, s33, v35
    v_lshlrev_b32 v28, 16, v36
    v_and_b32 v29, s33, v36
    v_lshlrev_b32 v30, 16, v37
    v_and_b32 v31, s33, v37
    s_mov_b32 s44, 0x000f000f
    s_mov_b32 s45, 0x0000000f
    s_bfe_u32 s31, s56, 0x40000
    s_mul_i32 s31, s31, s49
    s_add_u32 s31, s31, s52
    s_cmp_ge_u32 s28, 8
    s_barrier
    s_cbranch_scc1 L_nopoll
L_poll:
    buffer_load_dwordx3 v[8:10], v0, s[12:15], s40 offen sc1
    buffer_load_dwordx3 v[12:14], v0, s[12:15], s41 offen sc1
    s_waitcnt vmcnt(0)
    v_max3_u32 v16, v8, v9, v10
    v_max3_u32 v17, v12, v13, v14
    v_max_u32 v16, v16, v17
    v_cmp_eq_u32 vcc, -1, v16
    s_and_b64 exec, vcc, vcc
    s_cbranch_scc0 L_got
    s_sub_u32 s34, s34, 1
    s_cbranch_scc0 L_poll
L_got:
    s_mov_b64 exec, -1
    v_pk_add_f32 v[8:9], v[8:9], v[12:13]
    v_add_f32 v10, v10, v14
    s_nop 1
    v_permlane32_swap_b32 v8, v10
    v_permlane32_swap_b32 v9, v11
    v_pk_add_f32 v[8:9], v[8:9], v[10:11]
    s_nop 1
    v_permlane16_swap_b32 v8, v9
    v_add_f32 v8, v8, v9
    s_nop 1
    v_add_f32_dpp v8, v8, v8 row_ror:8 row_mask:0xf bank_mask:0xf
    s_nop 1
    v_add_f32_dpp v8, v8, v8 row_ror:4 row_mask:0xf bank_mask:0xf
    s_mov_b64 exec, s[44:45]
    ds_write_b32 v4, v8
    s_mov_b64 exec, -1
    s_waitcnt lgkmcnt(0)
L_nopoll:
    s_barrier
    ds_read_b128 v[8:11], v5 offset:768
    ds_read_b128 v[12:15], v5 offset:784
    s_and_b32 s38, s35, 0x010101
    s_bcnt1_i32_b32 s38, s38
    s_cmp_ge_u32 s38, 2
    s_waitcnt lgkmcnt(0)
    v_pk_add_f32 v[8:9], v[8:9], v[12:13]
    v_pk_add_f32 v[10:11], v[10:11], v[14:15]
    v_pk_add_f32 v[8:9], v[8:9], v[10:11]
    v_add_f32 v8, v8, v9
    v_mul_f32 v9, 0xb6b8aa3b, v8
    v_exp_f32 v9, v9
    v_mul_f32 v8, 0x36800000, v8
    v_add_f32 v9, 1.0, v9
    v_rcp_f32 v9, v9
    s_nop 0
    v_mul_f32 v8, v8, v9
    s_nop 1
    v_mul_f32_dpp v16, v8, v20 row_newbcast:0 row_mask:0xf bank_mask:0xf
    v_mul_f32_dpp v17, v8, v21 row_newbcast:0 row_mask:0xf bank_mask:0xf
    v_mul_f32_dpp v18, v8, v22 row_newbcast:1 row_mask:0xf bank_mask:0xf
    v_mul_f32_dpp v19, v8, v23 row_newbcast:1 row_mask:0xf bank_mask:0xf
    v_fmac_f32_dpp v16, v8, v24 row_newbcast:2 row_mask:0xf bank_mask:0xf
    v_fmac_f32_dpp v17, v8, v25 row_newbcast:2 row_mask:0xf bank_mask:0xf
    v_fmac_f32_dpp v18, v8, v26 row_newbcast:3 row_mask:0xf bank_mask:0xf
    v_fmac_f32_dpp v19, v8, v27 row_newbcast:3 row_mask:0xf bank_mask:0xf
    v_fmac_f32_dpp v16, v8, v28 row_newbcast:4 row_mask:0xf bank_mask:0xf
    v_fmac_f32_dpp v17, v8, v29 row_newbcast:4 row_mask:0xf bank_mask:0xf
    v_fmac_f32_dpp v18, v8, v30 row_newbcast:5 row_mask:0xf bank_mask:0xf
    v_fmac_f32_dpp v19, v8, v31 row_newbcast:5 row_mask:0xf bank_mask:0xf
    v_pk_add_f32 v[16:17], v[16:17], v[18:19]
    s_nop 1
    v_permlane32_swap_b32 v16, v17
    v_add_f32 v16, v16, v17
    v_mul_f32 v16, 0xbfb8aa3b, v16
    v_exp_f32 v16, v16
    s_nop 0
    v_add_f32 v16, 1.0, v16
    v_rcp_f32 v16, v16
    s_nop 0
    v_cvt_pk_bf16_f32 v16, v16, v16
    v_lshlrev_b32 v16, 16, v16
    ds_write_b32 v7, v16
    ds_read_b128 v[8:11], v6
    ds_read_b128 v[12:15], v6 offset:16
    v_lshlrev_b32 v20, 16, v104
    v_and_b32 v21, s33, v104
    v_lshlrev_b32 v22, 16, v105
    v_and_b32 v23, s33, v105
    v_lshlrev_b32 v24, 16, v106
    v_and_b32 v25, s33, v106
    v_lshlrev_b32 v26, 16, v107
    v_and_b32 v27, s33, v107
    s_waitcnt lgkmcnt(0)
    v_pk_mul_f32 v[20:21], v[20:21], v[8:9]
    v_pk_mul_f32 v[22:23], v[22:23], v[10:11]
    v_pk_mul_f32 v[24:25], v[24:25], v[12:13]
    v_pk_mul_f32 v[26:27], v[26:27], v[14:15]
    v_cvt_pk_bf16_f32 v104, v20, v21
    v_cvt_pk_bf16_f32 v105, v22, v23
    v_cvt_pk_bf16_f32 v106, v24, v25
    v_cvt_pk_bf16_f32 v107, v26, v27
    s_cbranch_scc1 L_through
    buffer_store_dwordx4 v[104:107], v2, s[8:11], s31 offen
    s_bfe_u32 s31, s56, 0x40004
    s_mul_i32 s31, s31, s49
    s_add_u32 s31, s31, s52
    v_lshlrev_b32 v16, 16, v108
    v_and_b32 v17, s33, v108
    v_lshlrev_b32 v18, 16, v109
    v_and_b32 v19, s33, v109
    v_pk_mul_f32 v[16:17], v[16:17], v[8:9]
    v_pk_mul_f32 v[18:19], v[18:19], v[10:11]
    v_cvt_pk_bf16_f32 v108, v16, v17
    v_cvt_pk_bf16_f32 v109, v18, v19
    v_lshlrev_b32 v20, 16, v110
    v_and_b32 v21, s33, v110
    v_lshlrev_b32 v22, 16, v111
    v_and_b32 v23, s33, v111
    v_pk_mul_f32 v[20:21], v[20:21], v[12:13]
    v_pk_mul_f32 v[22:23], v[22:23], v[14:15]
    v_cvt_pk_bf16_f32 v110, v20, v21
    v_cvt_pk_bf16_f32 v111, v22, v23
    buffer_store_dwordx4 v[108:111], v2, s[8:11], s31 offen sc1
    s_bfe_u32 s31, s54, 0x40000
    s_mul_i32 s31, s31, s49
    s_add_u32 s31, s31, s50
    v_lshlrev_b32 v16, 16, v40
    v_and_b32 v17, s33, v40
    v_lshlrev_b32 v18, 16, v41
    v_and_b32 v19, s33, v41
    v_pk_mul_f32 v[16:17], v[16:17], v[8:9]
    v_pk_mul_f32 v[18:19], v[18:19], v[10:11]
    v_cvt_pk_bf16_f32 v40, v16, v17
    v_cvt_pk_bf16_f32 v41, v18, v19
    v_lshlrev_b32 v20, 16, v42
    v_and_b32 v21, s33, v42
    v_lshlrev_b32 v22, 16, v43
    v_and_b32 v23, s33, v43
    v_pk_mul_f32 v[20:21], v[20:21], v[12:13]
    v_pk_mul_f32 v[22:23], v[22:23], v[14:15]
    v_cvt_pk_bf16_f32 v42, v20, v21
    v_cvt_pk_bf16_f32 v43, v22, v23
    buffer_store_dwordx4 v[40:43], v2, s[8:11], s31 offen sc1
    s_bfe_u32 s31, s54, 0x40004
    s_mul_i32 s31, s31, s49
    s_add_u32 s31, s31, s50
    v_lshlrev_b32 v16, 16, v44
    v_and_b32 v17, s33, v44
    v_lshlrev_b32 v18, 16, v45
    v_and_b32 v19, s33, v45
    v_pk_mul_f32 v[16:17], v[16:17], v[8:9]
    v_pk_mul_f32 v[18:19], v[18:19], v[10:11]
    v_cvt_pk_bf16_f32 v44, v16, v17
    v_cvt_pk_bf16_f32 v45, v18, v19
    v_lshlrev_b32 v20, 16, v46
    v_and_b32 v21, s33, v46
    v_lshlrev_b32 v22, 16, v47
    v_and_b32 v23, s33, v47
    v_pk_mul_f32 v[20:21], v[20:21], v[12:13]
    v_pk_mul_f32 v[22:23], v[22:23], v[14:15]
    v_cvt_pk_bf16_f32 v46, v20, v21
    v_cvt_pk_bf16_f32 v47, v22, v23
    buffer_store_dwordx4 v[44:47], v2, s[8:11], s31 offen sc1
    s_bfe_u32 s31, s57, 0x40000
    s_mul_i32 s31, s31, s49
    s_add_u32 s31, s31, s53
    v_lshlrev_b32 v16, 16, v136
    v_and_b32 v17, s33, v136
    v_lshlrev_b32 v18, 16, v137
    v_and_b32 v19, s33, v137
    v_pk_mul_f32 v[16:17], v[16:17], v[8:9]
    v_pk_mul_f32 v[18:19], v[18:19], v[10:11]
    v_cvt_pk_bf16_f32 v136, v16, v17
    v_cvt_pk_bf16_f32 v137, v18, v19
    v_lshlrev_b32 v20, 16, v138
    v_and_b32 v21, s33, v138
    v_lshlrev_b32 v22, 16, v139
    v_and_b32 v23, s33, v139
    v_pk_mul_f32 v[20:21], v[20:21], v[12:13]
    v_pk_mul_f32 v[22:23], v[22:23], v[14:15]
    v_cvt_pk_bf16_f32 v138, v20, v21
    v_cvt_pk_bf16_f32 v139, v22, v23
    buffer_store_dwordx4 v[136:139], v2, s[8:11], s31 offen sc1
    s_bfe_u32 s31, s57, 0x40004
    s_mul_i32 s31, s31, s49
    s_add_u32 s31, s31, s53
    v_lshlrev_b32 v16, 16, v140
    v_and_b32 v17, s33, v140
    v_lshlrev_b32 v18, 16, v141
    v_and_b32 v19, s33, v141
    v_pk_mul_f32 v[16:17], v[16:17], v[8:9]
    v_pk_mul_f32 v[18:19], v[18:19], v[10:11]
    v_cvt_pk_bf16_f32 v140, v16, v17
    v_cvt_pk_bf16_f32 v141, v18, v19
    v_lshlrev_b32 v20, 16, v142
    v_and_b32 v21, s33, v142
    v_lshlrev_b32 v22, 16, v143
    v_and_b32 v23, s33, v143
    v_pk_mul_f32 v[20:21], v[20:21], v[12:13]
    v_pk_mul_f32 v[22:23], v[22:23], v[14:15]
    v_cvt_pk_bf16_f32 v142, v20, v21
    v_cvt_pk_bf16_f32 v143, v22, v23
    buffer_store_dwordx4 v[140:143], v2, s[8:11], s31 offen sc1
    s_bfe_u32 s31, s55, 0x40000
    s_mul_i32 s31, s31, s49
    s_add_u32 s31, s31, s51
    v_lshlrev_b32 v16, 16, v72
    v_and_b32 v17, s33, v72
    v_lshlrev_b32 v18, 16, v73
    v_and_b32 v19, s33, v73
    v_pk_mul_f32 v[16:17], v[16:17], v[8:9]
    v_pk_mul_f32 v[18:19], v[18:19], v[10:11]
    v_cvt_pk_bf16_f32 v72, v16, v17
    v_cvt_pk_bf16_f32 v73, v18, v19
    v_lshlrev_b32 v20, 16, v74
    v_and_b32 v21, s33, v74
    v_lshlrev_b32 v22, 16, v75
    v_and_b32 v23, s33, v75
    v_pk_mul_f32 v[20:21], v[20:21], v[12:13]
    v_pk_mul_f32 v[22:23], v[22:23], v[14:15]
    v_cvt_pk_bf16_f32 v74, v20, v21
    v_cvt_pk_bf16_f32 v75, v22, v23
    buffer_store_dwordx4 v[72:75], v2, s[8:11], s31 offen
    s_bfe_u32 s31, s55, 0x40004
    s_mul_i32 s31, s31, s49
    s_add_u32 s31, s31, s51
    v_lshlrev_b32 v16, 16, v76
    v_and_b32 v17, s33, v76
    v_lshlrev_b32 v18, 16, v77
    v_and_b32 v19, s33, v77
    v_pk_mul_f32 v[16:17], v[16:17], v[8:9]
    v_pk_mul_f32 v[18:19], v[18:19], v[10:11]
    v_cvt_pk_bf16_f32 v76, v16, v17
    v_cvt_pk_bf16_f32 v77, v18, v19
    v_lshlrev_b32 v20, 16, v78
    v_and_b32 v21, s33, v78
    v_lshlrev_b32 v22, 16, v79
    v_and_b32 v23, s33, v79
    v_pk_mul_f32 v[20:21], v[20:21], v[12:13]
    v_pk_mul_f32 v[22:23], v[22:23], v[14:15]
    v_cvt_pk_bf16_f32 v78, v20, v21
    v_cvt_pk_bf16_f32 v79, v22, v23
    buffer_store_dwordx4 v[76:79], v2, s[8:11], s31 offen sc1
    s_bfe_u32 s31, s56, 0x40008
    s_mul_i32 s31, s31, s49
    s_add_u32 s31, s31, s52
    v_lshlrev_b32 v16, 16, v112
    v_and_b32 v17, s33, v112
    v_lshlrev_b32 v18, 16, v113
    v_and_b32 v19, s33, v113
    v_pk_mul_f32 v[16:17], v[16:17], v[8:9]
    v_pk_mul_f32 v[18:19], v[18:19], v[10:11]
    v_cvt_pk_bf16_f32 v112, v16, v17
    v_cvt_pk_bf16_f32 v113, v18, v19
    v_lshlrev_b32 v20, 16, v114
    v_and_b32 v21, s33, v114
    v_lshlrev_b32 v22, 16, v115
    v_and_b32 v23, s33, v115
    v_pk_mul_f32 v[20:21], v[20:21], v[12:13]
    v_pk_mul_f32 v[22:23], v[22:23], v[14:15]
    v_cvt_pk_bf16_f32 v114, v20, v21
    v_cvt_pk_bf16_f32 v115, v22, v23
    buffer_store_dwordx4 v[112:115], v2, s[8:11], s31 offen sc1
    s_bfe_u32 s31, s56, 0x4000c
    s_mul_i32 s31, s31, s49
    s_add_u32 s31, s31, s52
    v_lshlrev_b32 v16, 16, v116
    v_and_b32 v17, s33, v116
    v_lshlrev_b32 v18, 16, v117
    v_and_b32 v19, s33, v117
    v_pk_mul_f32 v[16:17], v[16:17], v[8:9]
    v_pk_mul_f32 v[18:19], v[18:19], v[10:11]
    v_cvt_pk_bf16_f32 v116, v16, v17
    v_cvt_pk_bf16_f32 v117, v18, v19
    v_lshlrev_b32 v20, 16, v118
    v_and_b32 v21, s33, v118
    v_lshlrev_b32 v22, 16, v119
    v_and_b32 v23, s33, v119
    v_pk_mul_f32 v[20:21], v[20:21], v[12:13]
    v_pk_mul_f32 v[22:23], v[22:23], v[14:15]
    v_cvt_pk_bf16_f32 v118, v20, v21
    v_cvt_pk_bf16_f32 v119, v22, v23
    buffer_store_dwordx4 v[116:119], v2, s[8:11], s31 offen sc1
    s_bfe_u32 s31, s54, 0x40008
    s_mul_i32 s31, s31, s49
    s_add_u32 s31, s31, s50
    v_lshlrev_b32 v16, 16, v48
    v_and_b32 v17, s33, v48
    v_lshlrev_b32 v18, 16, v49
    v_and_b32 v19, s33, v49
    v_pk_mul_f32 v[16:17], v[16:17], v[8:9]
    v_pk_mul_f32 v[18:19], v[18:19], v[10:11]
    v_cvt_pk_bf16_f32 v48, v16, v17
    v_cvt_pk_bf16_f32 v49, v18, v19
    v_lshlrev_b32 v20, 16, v50
    v_and_b32 v21, s33, v50
    v_lshlrev_b32 v22, 16, v51
    v_and_b32 v23, s33, v51
    v_pk_mul_f32 v[20:21], v[20:21], v[12:13]
    v_pk_mul_f32 v[22:23], v[22:23], v[14:15]
    v_cvt_pk_bf16_f32 v50, v20, v21
    v_cvt_pk_bf16_f32 v51, v22, v23
    buffer_store_dwordx4 v[48:51], v2, s[8:11], s31 offen sc1
    s_bfe_u32 s31, s54, 0x4000c
    s_mul_i32 s31, s31, s49
    s_add_u32 s31, s31, s50
    v_lshlrev_b32 v16, 16, v52
    v_and_b32 v17, s33, v52
    v_lshlrev_b32 v18, 16, v53
    v_and_b32 v19, s33, v53
    v_pk_mul_f32 v[16:17], v[16:17], v[8:9]
    v_pk_mul_f32 v[18:19], v[18:19], v[10:11]
    v_cvt_pk_bf16_f32 v52, v16, v17
    v_cvt_pk_bf16_f32 v53, v18, v19
    v_lshlrev_b32 v20, 16, v54
    v_and_b32 v21, s33, v54
    v_lshlrev_b32 v22, 16, v55
    v_and_b32 v23, s33, v55
    v_pk_mul_f32 v[20:21], v[20:21], v[12:13]
    v_pk_mul_f32 v[22:23], v[22:23], v[14:15]
    v_cvt_pk_bf16_f32 v54, v20, v21
    v_cvt_pk_bf16_f32 v55, v22, v23
    buffer_store_dwordx4 v[52:55], v2, s[8:11], s31 offen sc1
    s_bfe_u32 s31, s57, 0x40008
    s_mul_i32 s31, s31, s49
    s_add_u32 s31, s31, s53
    v_lshlrev_b32 v16, 16, v144
    v_and_b32 v17, s33, v144
    v_lshlrev_b32 v18, 16, v145
    v_and_b32 v19, s33, v145
    v_pk_mul_f32 v[16:17], v[16:17], v[8:9]
    v_pk_mul_f32 v[18:19], v[18:19], v[10:11]
    v_cvt_pk_bf16_f32 v144, v16, v17
    v_cvt_pk_bf16_f32 v145, v18, v19
    v_lshlrev_b32 v20, 16, v146
    v_and_b32 v21, s33, v146
    v_lshlrev_b32 v22, 16, v147
    v_and_b32 v23, s33, v147
    v_pk_mul_f32 v[20:21], v[20:21], v[12:13]
    v_pk_mul_f32 v[22:23], v[22:23], v[14:15]
    v_cvt_pk_bf16_f32 v146, v20, v21
    v_cvt_pk_bf16_f32 v147, v22, v23
    buffer_store_dwordx4 v[144:147], v2, s[8:11], s31 offen
    s_bfe_u32 s31, s57, 0x4000c
    s_mul_i32 s31, s31, s49
    s_add_u32 s31, s31, s53
    v_lshlrev_b32 v16, 16, v148
    v_and_b32 v17, s33, v148
    v_lshlrev_b32 v18, 16, v149
    v_and_b32 v19, s33, v149
    v_pk_mul_f32 v[16:17], v[16:17], v[8:9]
    v_pk_mul_f32 v[18:19], v[18:19], v[10:11]
    v_cvt_pk_bf16_f32 v148, v16, v17
    v_cvt_pk_bf16_f32 v149, v18, v19
    v_lshlrev_b32 v20, 16, v150
    v_and_b32 v21, s33, v150
    v_lshlrev_b32 v22, 16, v151
    v_and_b32 v23, s33, v151
    v_pk_mul_f32 v[20:21], v[20:21], v[12:13]
    v_pk_mul_f32 v[22:23], v[22:23], v[14:15]
    v_cvt_pk_bf16_f32 v150, v20, v21
    v_cvt_pk_bf16_f32 v151, v22, v23
    buffer_store_dwordx4 v[148:151], v2, s[8:11], s31 offen sc1
    s_bfe_u32 s31, s55, 0x40008
    s_mul_i32 s31, s31, s49
    s_add_u32 s31, s31, s51
    v_lshlrev_b32 v16, 16, v80
    v_and_b32 v17, s33, v80
    v_lshlrev_b32 v18, 16, v81
    v_and_b32 v19, s33, v81
    v_pk_mul_f32 v[16:17], v[16:17], v[8:9]
    v_pk_mul_f32 v[18:19], v[18:19], v[10:11]
    v_cvt_pk_bf16_f32 v80, v16, v17
    v_cvt_pk_bf16_f32 v81, v18, v19
    v_lshlrev_b32 v20, 16, v82
    v_and_b32 v21, s33, v82
    v_lshlrev_b32 v22, 16, v83
    v_and_b32 v23, s33, v83
    v_pk_mul_f32 v[20:21], v[20:21], v[12:13]
    v_pk_mul_f32 v[22:23], v[22:23], v[14:15]
    v_cvt_pk_bf16_f32 v82, v20, v21
    v_cvt_pk_bf16_f32 v83, v22, v23
    buffer_store_dwordx4 v[80:83], v2, s[8:11], s31 offen sc1
    s_bfe_u32 s31, s55, 0x4000c
    s_mul_i32 s31, s31, s49
    s_add_u32 s31, s31, s51
    v_lshlrev_b32 v16, 16, v84
    v_and_b32 v17, s33, v84
    v_lshlrev_b32 v18, 16, v85
    v_and_b32 v19, s33, v85
    v_pk_mul_f32 v[16:17], v[16:17], v[8:9]
    v_pk_mul_f32 v[18:19], v[18:19], v[10:11]
    v_cvt_pk_bf16_f32 v84, v16, v17
    v_cvt_pk_bf16_f32 v85, v18, v19
    v_lshlrev_b32 v20, 16, v86
    v_and_b32 v21, s33, v86
    v_lshlrev_b32 v22, 16, v87
    v_and_b32 v23, s33, v87
    v_pk_mul_f32 v[20:21], v[20:21], v[12:13]
    v_pk_mul_f32 v[22:23], v[22:23], v[14:15]
    v_cvt_pk_bf16_f32 v86, v20, v21
    v_cvt_pk_bf16_f32 v87, v22, v23
    buffer_store_dwordx4 v[84:87], v2, s[8:11], s31 offen sc1
    s_bfe_u32 s31, s56, 0x40010
    s_mul_i32 s31, s31, s49
    s_add_u32 s31, s31, s52
    v_lshlrev_b32 v16, 16, v120
    v_and_b32 v17, s33, v120
    v_lshlrev_b32 v18, 16, v121
    v_and_b32 v19, s33, v121
    v_pk_mul_f32 v[16:17], v[16:17], v[8:9]
    v_pk_mul_f32 v[18:19], v[18:19], v[10:11]
    v_cvt_pk_bf16_f32 v120, v16, v17
    v_cvt_pk_bf16_f32 v121, v18, v19
    v_lshlrev_b32 v20, 16, v122
    v_and_b32 v21, s33, v122
    v_lshlrev_b32 v22, 16, v123
    v_and_b32 v23, s33, v123
    v_pk_mul_f32 v[20:21], v[20:21], v[12:13]
    v_pk_mul_f32 v[22:23], v[22:23], v[14:15]
    v_cvt_pk_bf16_f32 v122, v20, v21
    v_cvt_pk_bf16_f32 v123, v22, v23
    buffer_store_dwordx4 v[120:123], v2, s[8:11], s31 offen sc1
    s_bfe_u32 s31, s56, 0x40014
    s_mul_i32 s31, s31, s49
    s_add_u32 s31, s31, s52
    v_lshlrev_b32 v16, 16, v124
    v_and_b32 v17, s33, v124
    v_lshlrev_b32 v18, 16, v125
    v_and_b32 v19, s33, v125
    v_pk_mul_f32 v[16:17], v[16:17], v[8:9]
    v_pk_mul_f32 v[18:19], v[18:19], v[10:11]
    v_cvt_pk_bf16_f32 v124, v16, v17
    v_cvt_pk_bf16_f32 v125, v18, v19
    v_lshlrev_b32 v20, 16, v126
    v_and_b32 v21, s33, v126
    v_lshlrev_b32 v22, 16, v127
    v_and_b32 v23, s33, v127
    v_pk_mul_f32 v[20:21], v[20:21], v[12:13]
    v_pk_mul_f32 v[22:23], v[22:23], v[14:15]
    v_cvt_pk_bf16_f32 v126, v20, v21
    v_cvt_pk_bf16_f32 v127, v22, v23
    buffer_store_dwordx4 v[124:127], v2, s[8:11], s31 offen sc1
    s_bfe_u32 s31, s54, 0x40010
    s_mul_i32 s31, s31, s49
    s_add_u32 s31, s31, s50
    v_lshlrev_b32 v16, 16, v56
    v_and_b32 v17, s33, v56
    v_lshlrev_b32 v18, 16, v57
    v_and_b32 v19, s33, v57
    v_pk_mul_f32 v[16:17], v[16:17], v[8:9]
    v_pk_mul_f32 v[18:19], v[18:19], v[10:11]
    v_cvt_pk_bf16_f32 v56, v16, v17
    v_cvt_pk_bf16_f32 v57, v18, v19
    v_lshlrev_b32 v20, 16, v58
    v_and_b32 v21, s33, v58
    v_lshlrev_b32 v22, 16, v59
    v_and_b32 v23, s33, v59
    v_pk_mul_f32 v[20:21], v[20:21], v[12:13]
    v_pk_mul_f32 v[22:23], v[22:23], v[14:15]
    v_cvt_pk_bf16_f32 v58, v20, v21
    v_cvt_pk_bf16_f32 v59, v22, v23
    buffer_store_dwordx4 v[56:59], v2, s[8:11], s31 offen
    s_bfe_u32 s31, s54, 0x40014
    s_mul_i32 s31, s31, s49
    s_add_u32 s31, s31, s50
    v_lshlrev_b32 v16, 16, v60
    v_and_b32 v17, s33, v60
    v_lshlrev_b32 v18, 16, v61
    v_and_b32 v19, s33, v61
    v_pk_mul_f32 v[16:17], v[16:17], v[8:9]
    v_pk_mul_f32 v[18:19], v[18:19], v[10:11]
    v_cvt_pk_bf16_f32 v60, v16, v17
    v_cvt_pk_bf16_f32 v61, v18, v19
    v_lshlrev_b32 v20, 16, v62
    v_and_b32 v21, s33, v62
    v_lshlrev_b32 v22, 16, v63
    v_and_b32 v23, s33, v63
    v_pk_mul_f32 v[20:21], v[20:21], v[12:13]
    v_pk_mul_f32 v[22:23], v[22:23], v[14:15]
    v_cvt_pk_bf16_f32 v62, v20, v21
    v_cvt_pk_bf16_f32 v63, v22, v23
    buffer_store_dwordx4 v[60:63], v2, s[8:11], s31 offen sc1
    s_bfe_u32 s31, s57, 0x40010
    s_mul_i32 s31, s31, s49
    s_add_u32 s31, s31, s53
    v_lshlrev_b32 v16, 16, v152
    v_and_b32 v17, s33, v152
    v_lshlrev_b32 v18, 16, v153
    v_and_b32 v19, s33, v153
    v_pk_mul_f32 v[16:17], v[16:17], v[8:9]
    v_pk_mul_f32 v[18:19], v[18:19], v[10:11]
    v_cvt_pk_bf16_f32 v152, v16, v17
    v_cvt_pk_bf16_f32 v153, v18, v19
    v_lshlrev_b32 v20, 16, v154
    v_and_b32 v21, s33, v154
    v_lshlrev_b32 v22, 16, v155
    v_and_b32 v23, s33, v155
    v_pk_mul_f32 v[20:21], v[20:21], v[12:13]
    v_pk_mul_f32 v[22:23], v[22:23], v[14:15]
    v_cvt_pk_bf16_f32 v154, v20, v21
    v_cvt_pk_bf16_f32 v155, v22, v23
    buffer_store_dwordx4 v[152:155], v2, s[8:11], s31 offen sc1
    s_bfe_u32 s31, s57, 0x40014
    s_mul_i32 s31, s31, s49
    s_add_u32 s31, s31, s53
    v_lshlrev_b32 v16, 16, v156
    v_and_b32 v17, s33, v156
    v_lshlrev_b32 v18, 16, v157
    v_and_b32 v19, s33, v157
    v_pk_mul_f32 v[16:17], v[16:17], v[8:9]
    v_pk_mul_f32 v[18:19], v[18:19], v[10:11]
    v_cvt_pk_bf16_f32 v156, v16, v17
    v_cvt_pk_bf16_f32 v157, v18, v19
    v_lshlrev_b32 v20, 16, v158
    v_and_b32 v21, s33, v158
    v_lshlrev_b32 v22, 16, v159
    v_and_b32 v23, s33, v159
    v_pk_mul_f32 v[20:21], v[20:21], v[12:13]
    v_pk_mul_f32 v[22:23], v[22:23], v[14:15]
    v_cvt_pk_bf16_f32 v158, v20, v21
    v_cvt_pk_bf16_f32 v159, v22, v23
    buffer_store_dwordx4 v[156:159], v2, s[8:11], s31 offen sc1
    s_bfe_u32 s31, s55, 0x40010
    s_mul_i32 s31, s31, s49
    s_add_u32 s31, s31, s51
    v_lshlrev_b32 v16, 16, v88
    v_and_b32 v17, s33, v88
    v_lshlrev_b32 v18, 16, v89
    v_and_b32 v19, s33, v89
    v_pk_mul_f32 v[16:17], v[16:17], v[8:9]
    v_pk_mul_f32 v[18:19], v[18:19], v[10:11]
    v_cvt_pk_bf16_f32 v88, v16, v17
    v_cvt_pk_bf16_f32 v89, v18, v19
    v_lshlrev_b32 v20, 16, v90
    v_and_b32 v21, s33, v90
    v_lshlrev_b32 v22, 16, v91
    v_and_b32 v23, s33, v91
    v_pk_mul_f32 v[20:21], v[20:21], v[12:13]
    v_pk_mul_f32 v[22:23], v[22:23], v[14:15]
    v_cvt_pk_bf16_f32 v90, v20, v21
    v_cvt_pk_bf16_f32 v91, v22, v23
    buffer_store_dwordx4 v[88:91], v2, s[8:11], s31 offen sc1
    s_bfe_u32 s31, s55, 0x40014
    s_mul_i32 s31, s31, s49
    s_add_u32 s31, s31, s51
    v_lshlrev_b32 v16, 16, v92
    v_and_b32 v17, s33, v92
    v_lshlrev_b32 v18, 16, v93
    v_and_b32 v19, s33, v93
    v_pk_mul_f32 v[16:17], v[16:17], v[8:9]
    v_pk_mul_f32 v[18:19], v[18:19], v[10:11]
    v_cvt_pk_bf16_f32 v92, v16, v17
    v_cvt_pk_bf16_f32 v93, v18, v19
    v_lshlrev_b32 v20, 16, v94
    v_and_b32 v21, s33, v94
    v_lshlrev_b32 v22, 16, v95
    v_and_b32 v23, s33, v95
    v_pk_mul_f32 v[20:21], v[20:21], v[12:13]
    v_pk_mul_f32 v[22:23], v[22:23], v[14:15]
    v_cvt_pk_bf16_f32 v94, v20, v21
    v_cvt_pk_bf16_f32 v95, v22, v23
    buffer_store_dwordx4 v[92:95], v2, s[8:11], s31 offen sc1
    s_bfe_u32 s31, s56, 0x40018
    s_mul_i32 s31, s31, s49
    s_add_u32 s31, s31, s52
    v_lshlrev_b32 v16, 16, v128
    v_and_b32 v17, s33, v128
    v_lshlrev_b32 v18, 16, v129
    v_and_b32 v19, s33, v129
    v_pk_mul_f32 v[16:17], v[16:17], v[8:9]
    v_pk_mul_f32 v[18:19], v[18:19], v[10:11]
    v_cvt_pk_bf16_f32 v128, v16, v17
    v_cvt_pk_bf16_f32 v129, v18, v19
    v_lshlrev_b32 v20, 16, v130
    v_and_b32 v21, s33, v130
    v_lshlrev_b32 v22, 16, v131
    v_and_b32 v23, s33, v131
    v_pk_mul_f32 v[20:21], v[20:21], v[12:13]
    v_pk_mul_f32 v[22:23], v[22:23], v[14:15]
    v_cvt_pk_bf16_f32 v130, v20, v21
    v_cvt_pk_bf16_f32 v131, v22, v23
    buffer_store_dwordx4 v[128:131], v2, s[8:11], s31 offen
    s_bfe_u32 s31, s56, 0x4001c
    s_mul_i32 s31, s31, s49
    s_add_u32 s31, s31, s52
    v_lshlrev_b32 v16, 16, v132
    v_and_b32 v17, s33, v132
    v_lshlrev_b32 v18, 16, v133
    v_and_b32 v19, s33, v133
    v_pk_mul_f32 v[16:17], v[16:17], v[8:9]
    v_pk_mul_f32 v[18:19], v[18:19], v[10:11]
    v_cvt_pk_bf16_f32 v132, v16, v17
    v_cvt_pk_bf16_f32 v133, v18, v19
    v_lshlrev_b32 v20, 16, v134
    v_and_b32 v21, s33, v134
    v_lshlrev_b32 v22, 16, v135
    v_and_b32 v23, s33, v135
    v_pk_mul_f32 v[20:21], v[20:21], v[12:13]
    v_pk_mul_f32 v[22:23], v[22:23], v[14:15]
    v_cvt_pk_bf16_f32 v134, v20, v21
    v_cvt_pk_bf16_f32 v135, v22, v23
    buffer_store_dwordx4 v[132:135], v2, s[8:11], s31 offen sc1
    s_bfe_u32 s31, s54, 0x40018
    s_mul_i32 s31, s31, s49
    s_add_u32 s31, s31, s50
    v_lshlrev_b32 v16, 16, v64
    v_and_b32 v17, s33, v64
    v_lshlrev_b32 v18, 16, v65
    v_and_b32 v19, s33, v65
    v_pk_mul_f32 v[16:17], v[16:17], v[8:9]
    v_pk_mul_f32 v[18:19], v[18:19], v[10:11]
    v_cvt_pk_bf16_f32 v64, v16, v17
    v_cvt_pk_bf16_f32 v65, v18, v19
    v_lshlrev_b32 v20, 16, v66
    v_and_b32 v21, s33, v66
    v_lshlrev_b32 v22, 16, v67
    v_and_b32 v23, s33, v67
    v_pk_mul_f32 v[20:21], v[20:21], v[12:13]
    v_pk_mul_f32 v[22:23], v[22:23], v[14:15]
    v_cvt_pk_bf16_f32 v66, v20, v21
    v_cvt_pk_bf16_f32 v67, v22, v23
    buffer_store_dwordx4 v[64:67], v2, s[8:11], s31 offen sc1
    s_bfe_u32 s31, s54, 0x4001c
    s_mul_i32 s31, s31, s49
    s_add_u32 s31, s31, s50
    v_lshlrev_b32 v16, 16, v68
    v_and_b32 v17, s33, v68
    v_lshlrev_b32 v18, 16, v69
    v_and_b32 v19, s33, v69
    v_pk_mul_f32 v[16:17], v[16:17], v[8:9]
    v_pk_mul_f32 v[18:19], v[18:19], v[10:11]
    v_cvt_pk_bf16_f32 v68, v16, v17
    v_cvt_pk_bf16_f32 v69, v18, v19
    v_lshlrev_b32 v20, 16, v70
    v_and_b32 v21, s33, v70
    v_lshlrev_b32 v22, 16, v71
    v_and_b32 v23, s33, v71
    v_pk_mul_f32 v[20:21], v[20:21], v[12:13]
    v_pk_mul_f32 v[22:23], v[22:23], v[14:15]
    v_cvt_pk_bf16_f32 v70, v20, v21
    v_cvt_pk_bf16_f32 v71, v22, v23
    buffer_store_dwordx4 v[68:71], v2, s[8:11], s31 offen sc1
    s_bfe_u32 s31, s57, 0x40018
    s_mul_i32 s31, s31, s49
    s_add_u32 s31, s31, s53
    v_lshlrev_b32 v16, 16, v160
    v_and_b32 v17, s33, v160
    v_lshlrev_b32 v18, 16, v161
    v_and_b32 v19, s33, v161
    v_pk_mul_f32 v[16:17], v[16:17], v[8:9]
    v_pk_mul_f32 v[18:19], v[18:19], v[10:11]
    v_cvt_pk_bf16_f32 v160, v16, v17
    v_cvt_pk_bf16_f32 v161, v18, v19
    v_lshlrev_b32 v20, 16, v162
    v_and_b32 v21, s33, v162
    v_lshlrev_b32 v22, 16, v163
    v_and_b32 v23, s33, v163
    v_pk_mul_f32 v[20:21], v[20:21], v[12:13]
    v_pk_mul_f32 v[22:23], v[22:23], v[14:15]
    v_cvt_pk_bf16_f32 v162, v20, v21
    v_cvt_pk_bf16_f32 v163, v22, v23
    buffer_store_dwordx4 v[160:163], v2, s[8:11], s31 offen sc1
    s_bfe_u32 s31, s57, 0x4001c
    s_mul_i32 s31, s31, s49
    s_add_u32 s31, s31, s53
    v_lshlrev_b32 v16, 16, v164
    v_and_b32 v17, s33, v164
    v_lshlrev_b32 v18, 16, v165
    v_and_b32 v19, s33, v165
    v_pk_mul_f32 v[16:17], v[16:17], v[8:9]
    v_pk_mul_f32 v[18:19], v[18:19], v[10:11]
    v_cvt_pk_bf16_f32 v164, v16, v17
    v_cvt_pk_bf16_f32 v165, v18, v19
    v_lshlrev_b32 v20, 16, v166
    v_and_b32 v21, s33, v166
    v_lshlrev_b32 v22, 16, v167
    v_and_b32 v23, s33, v167
    v_pk_mul_f32 v[20:21], v[20:21], v[12:13]
    v_pk_mul_f32 v[22:23], v[22:23], v[14:15]
    v_cvt_pk_bf16_f32 v166, v20, v21
    v_cvt_pk_bf16_f32 v167, v22, v23
    buffer_store_dwordx4 v[164:167], v2, s[8:11], s31 offen sc1
    s_bfe_u32 s31, s55, 0x40018
    s_mul_i32 s31, s31, s49
    s_add_u32 s31, s31, s51
    v_lshlrev_b32 v16, 16, v96
    v_and_b32 v17, s33, v96
    v_lshlrev_b32 v18, 16, v97
    v_and_b32 v19, s33, v97
    v_pk_mul_f32 v[16:17], v[16:17], v[8:9]
    v_pk_mul_f32 v[18:19], v[18:19], v[10:11]
    v_cvt_pk_bf16_f32 v96, v16, v17
    v_cvt_pk_bf16_f32 v97, v18, v19
    v_lshlrev_b32 v20, 16, v98
    v_and_b32 v21, s33, v98
    v_lshlrev_b32 v22, 16, v99
    v_and_b32 v23, s33, v99
    v_pk_mul_f32 v[20:21], v[20:21], v[12:13]
    v_pk_mul_f32 v[22:23], v[22:23], v[14:15]
    v_cvt_pk_bf16_f32 v98, v20, v21
    v_cvt_pk_bf16_f32 v99, v22, v23
    buffer_store_dwordx4 v[96:99], v2, s[8:11], s31 offen
    s_bfe_u32 s31, s55, 0x4001c
    s_mul_i32 s31, s31, s49
    s_add_u32 s31, s31, s51
    v_lshlrev_b32 v16, 16, v100
    v_and_b32 v17, s33, v100
    v_lshlrev_b32 v18, 16, v101
    v_and_b32 v19, s33, v101
    v_pk_mul_f32 v[16:17], v[16:17], v[8:9]
    v_pk_mul_f32 v[18:19], v[18:19], v[10:11]
    v_cvt_pk_bf16_f32 v100, v16, v17
    v_cvt_pk_bf16_f32 v101, v18, v19
    v_lshlrev_b32 v20, 16, v102
    v_and_b32 v21, s33, v102
    v_lshlrev_b32 v22, 16, v103
    v_and_b32 v23, s33, v103
    v_pk_mul_f32 v[20:21], v[20:21], v[12:13]
    v_pk_mul_f32 v[22:23], v[22:23], v[14:15]
    v_cvt_pk_bf16_f32 v102, v20, v21
    v_cvt_pk_bf16_f32 v103, v22, v23
    buffer_store_dwordx4 v[100:103], v2, s[8:11], s31 offen sc1
    s_endpgm
L_through:
    buffer_store_dwordx4 v[104:107], v2, s[8:11], s31 offen sc1
    s_bfe_u32 s31, s56, 0x40004
    s_mul_i32 s31, s31, s49
    s_add_u32 s31, s31, s52
    v_lshlrev_b32 v16, 16, v108
    v_and_b32 v17, s33, v108
    v_lshlrev_b32 v18, 16, v109
    v_and_b32 v19, s33, v109
    v_pk_mul_f32 v[16:17], v[16:17], v[8:9]
    v_pk_mul_f32 v[18:19], v[18:19], v[10:11]
    v_cvt_pk_bf16_f32 v108, v16, v17
    v_cvt_pk_bf16_f32 v109, v18, v19
    v_lshlrev_b32 v20, 16, v110
    v_and_b32 v21, s33, v110
    v_lshlrev_b32 v22, 16, v111
    v_and_b32 v23, s33, v111
    v_pk_mul_f32 v[20:21], v[20:21], v[12:13]
    v_pk_mul_f32 v[22:23], v[22:23], v[14:15]
    v_cvt_pk_bf16_f32 v110, v20, v21
    v_cvt_pk_bf16_f32 v111, v22, v23
    buffer_store_dwordx4 v[108:111], v2, s[8:11], s31 offen sc1
    s_bfe_u32 s31, s54, 0x40000
    s_mul_i32 s31, s31, s49
    s_add_u32 s31, s31, s50
    v_lshlrev_b32 v16, 16, v40
    v_and_b32 v17, s33, v40
    v_lshlrev_b32 v18, 16, v41
    v_and_b32 v19, s33, v41
    v_pk_mul_f32 v[16:17], v[16:17], v[8:9]
    v_pk_mul_f32 v[18:19], v[18:19], v[10:11]
    v_cvt_pk_bf16_f32 v40, v16, v17
    v_cvt_pk_bf16_f32 v41, v18, v19
    v_lshlrev_b32 v20, 16, v42
    v_and_b32 v21, s33, v42
    v_lshlrev_b32 v22, 16, v43
    v_and_b32 v23, s33, v43
    v_pk_mul_f32 v[20:21], v[20:21], v[12:13]
    v_pk_mul_f32 v[22:23], v[22:23], v[14:15]
    v_cvt_pk_bf16_f32 v42, v20, v21
    v_cvt_pk_bf16_f32 v43, v22, v23
    buffer_store_dwordx4 v[40:43], v2, s[8:11], s31 offen sc1
    s_bfe_u32 s31, s54, 0x40004
    s_mul_i32 s31, s31, s49
    s_add_u32 s31, s31, s50
    v_lshlrev_b32 v16, 16, v44
    v_and_b32 v17, s33, v44
    v_lshlrev_b32 v18, 16, v45
    v_and_b32 v19, s33, v45
    v_pk_mul_f32 v[16:17], v[16:17], v[8:9]
    v_pk_mul_f32 v[18:19], v[18:19], v[10:11]
    v_cvt_pk_bf16_f32 v44, v16, v17
    v_cvt_pk_bf16_f32 v45, v18, v19
    v_lshlrev_b32 v20, 16, v46
    v_and_b32 v21, s33, v46
    v_lshlrev_b32 v22, 16, v47
    v_and_b32 v23, s33, v47
    v_pk_mul_f32 v[20:21], v[20:21], v[12:13]
    v_pk_mul_f32 v[22:23], v[22:23], v[14:15]
    v_cvt_pk_bf16_f32 v46, v20, v21
    v_cvt_pk_bf16_f32 v47, v22, v23
    buffer_store_dwordx4 v[44:47], v2, s[8:11], s31 offen sc1
    s_bfe_u32 s31, s57, 0x40000
    s_mul_i32 s31, s31, s49
    s_add_u32 s31, s31, s53
    v_lshlrev_b32 v16, 16, v136
    v_and_b32 v17, s33, v136
    v_lshlrev_b32 v18, 16, v137
    v_and_b32 v19, s33, v137
    v_pk_mul_f32 v[16:17], v[16:17], v[8:9]
    v_pk_mul_f32 v[18:19], v[18:19], v[10:11]
    v_cvt_pk_bf16_f32 v136, v16, v17
    v_cvt_pk_bf16_f32 v137, v18, v19
    v_lshlrev_b32 v20, 16, v138
    v_and_b32 v21, s33, v138
    v_lshlrev_b32 v22, 16, v139
    v_and_b32 v23, s33, v139
    v_pk_mul_f32 v[20:21], v[20:21], v[12:13]
    v_pk_mul_f32 v[22:23], v[22:23], v[14:15]
    v_cvt_pk_bf16_f32 v138, v20, v21
    v_cvt_pk_bf16_f32 v139, v22, v23
    buffer_store_dwordx4 v[136:139], v2, s[8:11], s31 offen sc1
    s_bfe_u32 s31, s57, 0x40004
    s_mul_i32 s31, s31, s49
    s_add_u32 s31, s31, s53
    v_lshlrev_b32 v16, 16, v140
    v_and_b32 v17, s33, v140
    v_lshlrev_b32 v18, 16, v141
    v_and_b32 v19, s33, v141
    v_pk_mul_f32 v[16:17], v[16:17], v[8:9]
    v_pk_mul_f32 v[18:19], v[18:19], v[10:11]
    v_cvt_pk_bf16_f32 v140, v16, v17
    v_cvt_pk_bf16_f32 v141, v18, v19
    v_lshlrev_b32 v20, 16, v142
    v_and_b32 v21, s33, v142
    v_lshlrev_b32 v22, 16, v143
    v_and_b32 v23, s33, v143
    v_pk_mul_f32 v[20:21], v[20:21], v[12:13]
    v_pk_mul_f32 v[22:23], v[22:23], v[14:15]
    v_cvt_pk_bf16_f32 v142, v20, v21
    v_cvt_pk_bf16_f32 v143, v22, v23
    buffer_store_dwordx4 v[140:143], v2, s[8:11], s31 offen sc1
    s_bfe_u32 s31, s55, 0x40000
    s_mul_i32 s31, s31, s49
    s_add_u32 s31, s31, s51
    v_lshlrev_b32 v16, 16, v72
    v_and_b32 v17, s33, v72
    v_lshlrev_b32 v18, 16, v73
    v_and_b32 v19, s33, v73
    v_pk_mul_f32 v[16:17], v[16:17], v[8:9]
    v_pk_mul_f32 v[18:19], v[18:19], v[10:11]
    v_cvt_pk_bf16_f32 v72, v16, v17
    v_cvt_pk_bf16_f32 v73, v18, v19
    v_lshlrev_b32 v20, 16, v74
    v_and_b32 v21, s33, v74
    v_lshlrev_b32 v22, 16, v75
    v_and_b32 v23, s33, v75
    v_pk_mul_f32 v[20:21], v[20:21], v[12:13]
    v_pk_mul_f32 v[22:23], v[22:23], v[14:15]
    v_cvt_pk_bf16_f32 v74, v20, v21
    v_cvt_pk_bf16_f32 v75, v22, v23
    buffer_store_dwordx4 v[72:75], v2, s[8:11], s31 offen sc1
    s_bfe_u32 s31, s55, 0x40004
    s_mul_i32 s31, s31, s49
    s_add_u32 s31, s31, s51
    v_lshlrev_b32 v16, 16, v76
    v_and_b32 v17, s33, v76
    v_lshlrev_b32 v18, 16, v77
    v_and_b32 v19, s33, v77
    v_pk_mul_f32 v[16:17], v[16:17], v[8:9]
    v_pk_mul_f32 v[18:19], v[18:19], v[10:11]
    v_cvt_pk_bf16_f32 v76, v16, v17
    v_cvt_pk_bf16_f32 v77, v18, v19
    v_lshlrev_b32 v20, 16, v78
    v_and_b32 v21, s33, v78
    v_lshlrev_b32 v22, 16, v79
    v_and_b32 v23, s33, v79
    v_pk_mul_f32 v[20:21], v[20:21], v[12:13]
    v_pk_mul_f32 v[22:23], v[22:23], v[14:15]
    v_cvt_pk_bf16_f32 v78, v20, v21
    v_cvt_pk_bf16_f32 v79, v22, v23
    buffer_store_dwordx4 v[76:79], v2, s[8:11], s31 offen sc1
    s_bfe_u32 s31, s56, 0x40008
    s_mul_i32 s31, s31, s49
    s_add_u32 s31, s31, s52
    v_lshlrev_b32 v16, 16, v112
    v_and_b32 v17, s33, v112
    v_lshlrev_b32 v18, 16, v113
    v_and_b32 v19, s33, v113
    v_pk_mul_f32 v[16:17], v[16:17], v[8:9]
    v_pk_mul_f32 v[18:19], v[18:19], v[10:11]
    v_cvt_pk_bf16_f32 v112, v16, v17
    v_cvt_pk_bf16_f32 v113, v18, v19
    v_lshlrev_b32 v20, 16, v114
    v_and_b32 v21, s33, v114
    v_lshlrev_b32 v22, 16, v115
    v_and_b32 v23, s33, v115
    v_pk_mul_f32 v[20:21], v[20:21], v[12:13]
    v_pk_mul_f32 v[22:23], v[22:23], v[14:15]
    v_cvt_pk_bf16_f32 v114, v20, v21
    v_cvt_pk_bf16_f32 v115, v22, v23
    buffer_store_dwordx4 v[112:115], v2, s[8:11], s31 offen sc1
    s_bfe_u32 s31, s56, 0x4000c
    s_mul_i32 s31, s31, s49
    s_add_u32 s31, s31, s52
    v_lshlrev_b32 v16, 16, v116
    v_and_b32 v17, s33, v116
    v_lshlrev_b32 v18, 16, v117
    v_and_b32 v19, s33, v117
    v_pk_mul_f32 v[16:17], v[16:17], v[8:9]
    v_pk_mul_f32 v[18:19], v[18:19], v[10:11]
    v_cvt_pk_bf16_f32 v116, v16, v17
    v_cvt_pk_bf16_f32 v117, v18, v19
    v_lshlrev_b32 v20, 16, v118
    v_and_b32 v21, s33, v118
    v_lshlrev_b32 v22, 16, v119
    v_and_b32 v23, s33, v119
    v_pk_mul_f32 v[20:21], v[20:21], v[12:13]
    v_pk_mul_f32 v[22:23], v[22:23], v[14:15]
    v_cvt_pk_bf16_f32 v118, v20, v21
    v_cvt_pk_bf16_f32 v119, v22, v23
    buffer_store_dwordx4 v[116:119], v2, s[8:11], s31 offen sc1
    s_bfe_u32 s31, s54, 0x40008
    s_mul_i32 s31, s31, s49
    s_add_u32 s31, s31, s50
    v_lshlrev_b32 v16, 16, v48
    v_and_b32 v17, s33, v48
    v_lshlrev_b32 v18, 16, v49
    v_and_b32 v19, s33, v49
    v_pk_mul_f32 v[16:17], v[16:17], v[8:9]
    v_pk_mul_f32 v[18:19], v[18:19], v[10:11]
    v_cvt_pk_bf16_f32 v48, v16, v17
    v_cvt_pk_bf16_f32 v49, v18, v19
    v_lshlrev_b32 v20, 16, v50
    v_and_b32 v21, s33, v50
    v_lshlrev_b32 v22, 16, v51
    v_and_b32 v23, s33, v51
    v_pk_mul_f32 v[20:21], v[20:21], v[12:13]
    v_pk_mul_f32 v[22:23], v[22:23], v[14:15]
    v_cvt_pk_bf16_f32 v50, v20, v21
    v_cvt_pk_bf16_f32 v51, v22, v23
    buffer_store_dwordx4 v[48:51], v2, s[8:11], s31 offen sc1
    s_bfe_u32 s31, s54, 0x4000c
    s_mul_i32 s31, s31, s49
    s_add_u32 s31, s31, s50
    v_lshlrev_b32 v16, 16, v52
    v_and_b32 v17, s33, v52
    v_lshlrev_b32 v18, 16, v53
    v_and_b32 v19, s33, v53
    v_pk_mul_f32 v[16:17], v[16:17], v[8:9]
    v_pk_mul_f32 v[18:19], v[18:19], v[10:11]
    v_cvt_pk_bf16_f32 v52, v16, v17
    v_cvt_pk_bf16_f32 v53, v18, v19
    v_lshlrev_b32 v20, 16, v54
    v_and_b32 v21, s33, v54
    v_lshlrev_b32 v22, 16, v55
    v_and_b32 v23, s33, v55
    v_pk_mul_f32 v[20:21], v[20:21], v[12:13]
    v_pk_mul_f32 v[22:23], v[22:23], v[14:15]
    v_cvt_pk_bf16_f32 v54, v20, v21
    v_cvt_pk_bf16_f32 v55, v22, v23
    buffer_store_dwordx4 v[52:55], v2, s[8:11], s31 offen sc1
    s_bfe_u32 s31, s57, 0x40008
    s_mul_i32 s31, s31, s49
    s_add_u32 s31, s31, s53
    v_lshlrev_b32 v16, 16, v144
    v_and_b32 v17, s33, v144
    v_lshlrev_b32 v18, 16, v145
    v_and_b32 v19, s33, v145
    v_pk_mul_f32 v[16:17], v[16:17], v[8:9]
    v_pk_mul_f32 v[18:19], v[18:19], v[10:11]
    v_cvt_pk_bf16_f32 v144, v16, v17
    v_cvt_pk_bf16_f32 v145, v18, v19
    v_lshlrev_b32 v20, 16, v146
    v_and_b32 v21, s33, v146
    v_lshlrev_b32 v22, 16, v147
    v_and_b32 v23, s33, v147
    v_pk_mul_f32 v[20:21], v[20:21], v[12:13]
    v_pk_mul_f32 v[22:23], v[22:23], v[14:15]
    v_cvt_pk_bf16_f32 v146, v20, v21
    v_cvt_pk_bf16_f32 v147, v22, v23
    buffer_store_dwordx4 v[144:147], v2, s[8:11], s31 offen sc1
    s_bfe_u32 s31, s57, 0x4000c
    s_mul_i32 s31, s31, s49
    s_add_u32 s31, s31, s53
    v_lshlrev_b32 v16, 16, v148
    v_and_b32 v17, s33, v148
    v_lshlrev_b32 v18, 16, v149
    v_and_b32 v19, s33, v149
    v_pk_mul_f32 v[16:17], v[16:17], v[8:9]
    v_pk_mul_f32 v[18:19], v[18:19], v[10:11]
    v_cvt_pk_bf16_f32 v148, v16, v17
    v_cvt_pk_bf16_f32 v149, v18, v19
    v_lshlrev_b32 v20, 16, v150
    v_and_b32 v21, s33, v150
    v_lshlrev_b32 v22, 16, v151
    v_and_b32 v23, s33, v151
    v_pk_mul_f32 v[20:21], v[20:21], v[12:13]
    v_pk_mul_f32 v[22:23], v[22:23], v[14:15]
    v_cvt_pk_bf16_f32 v150, v20, v21
    v_cvt_pk_bf16_f32 v151, v22, v23
    buffer_store_dwordx4 v[148:151], v2, s[8:11], s31 offen sc1
    s_bfe_u32 s31, s55, 0x40008
    s_mul_i32 s31, s31, s49
    s_add_u32 s31, s31, s51
    v_lshlrev_b32 v16, 16, v80
    v_and_b32 v17, s33, v80
    v_lshlrev_b32 v18, 16, v81
    v_and_b32 v19, s33, v81
    v_pk_mul_f32 v[16:17], v[16:17], v[8:9]
    v_pk_mul_f32 v[18:19], v[18:19], v[10:11]
    v_cvt_pk_bf16_f32 v80, v16, v17
    v_cvt_pk_bf16_f32 v81, v18, v19
    v_lshlrev_b32 v20, 16, v82
    v_and_b32 v21, s33, v82
    v_lshlrev_b32 v22, 16, v83
    v_and_b32 v23, s33, v83
    v_pk_mul_f32 v[20:21], v[20:21], v[12:13]
    v_pk_mul_f32 v[22:23], v[22:23], v[14:15]
    v_cvt_pk_bf16_f32 v82, v20, v21
    v_cvt_pk_bf16_f32 v83, v22, v23
    buffer_store_dwordx4 v[80:83], v2, s[8:11], s31 offen sc1
    s_bfe_u32 s31, s55, 0x4000c
    s_mul_i32 s31, s31, s49
    s_add_u32 s31, s31, s51
    v_lshlrev_b32 v16, 16, v84
    v_and_b32 v17, s33, v84
    v_lshlrev_b32 v18, 16, v85
    v_and_b32 v19, s33, v85
    v_pk_mul_f32 v[16:17], v[16:17], v[8:9]
    v_pk_mul_f32 v[18:19], v[18:19], v[10:11]
    v_cvt_pk_bf16_f32 v84, v16, v17
    v_cvt_pk_bf16_f32 v85, v18, v19
    v_lshlrev_b32 v20, 16, v86
    v_and_b32 v21, s33, v86
    v_lshlrev_b32 v22, 16, v87
    v_and_b32 v23, s33, v87
    v_pk_mul_f32 v[20:21], v[20:21], v[12:13]
    v_pk_mul_f32 v[22:23], v[22:23], v[14:15]
    v_cvt_pk_bf16_f32 v86, v20, v21
    v_cvt_pk_bf16_f32 v87, v22, v23
    buffer_store_dwordx4 v[84:87], v2, s[8:11], s31 offen sc1
    s_bfe_u32 s31, s56, 0x40010
    s_mul_i32 s31, s31, s49
    s_add_u32 s31, s31, s52
    v_lshlrev_b32 v16, 16, v120
    v_and_b32 v17, s33, v120
    v_lshlrev_b32 v18, 16, v121
    v_and_b32 v19, s33, v121
    v_pk_mul_f32 v[16:17], v[16:17], v[8:9]
    v_pk_mul_f32 v[18:19], v[18:19], v[10:11]
    v_cvt_pk_bf16_f32 v120, v16, v17
    v_cvt_pk_bf16_f32 v121, v18, v19
    v_lshlrev_b32 v20, 16, v122
    v_and_b32 v21, s33, v122
    v_lshlrev_b32 v22, 16, v123
    v_and_b32 v23, s33, v123
    v_pk_mul_f32 v[20:21], v[20:21], v[12:13]
    v_pk_mul_f32 v[22:23], v[22:23], v[14:15]
    v_cvt_pk_bf16_f32 v122, v20, v21
    v_cvt_pk_bf16_f32 v123, v22, v23
    buffer_store_dwordx4 v[120:123], v2, s[8:11], s31 offen sc1
    s_bfe_u32 s31, s56, 0x40014
    s_mul_i32 s31, s31, s49
    s_add_u32 s31, s31, s52
    v_lshlrev_b32 v16, 16, v124
    v_and_b32 v17, s33, v124
    v_lshlrev_b32 v18, 16, v125
    v_and_b32 v19, s33, v125
    v_pk_mul_f32 v[16:17], v[16:17], v[8:9]
    v_pk_mul_f32 v[18:19], v[18:19], v[10:11]
    v_cvt_pk_bf16_f32 v124, v16, v17
    v_cvt_pk_bf16_f32 v125, v18, v19
    v_lshlrev_b32 v20, 16, v126
    v_and_b32 v21, s33, v126
    v_lshlrev_b32 v22, 16, v127
    v_and_b32 v23, s33, v127
    v_pk_mul_f32 v[20:21], v[20:21], v[12:13]
    v_pk_mul_f32 v[22:23], v[22:23], v[14:15]
    v_cvt_pk_bf16_f32 v126, v20, v21
    v_cvt_pk_bf16_f32 v127, v22, v23
    buffer_store_dwordx4 v[124:127], v2, s[8:11], s31 offen sc1
    s_bfe_u32 s31, s54, 0x40010
    s_mul_i32 s31, s31, s49
    s_add_u32 s31, s31, s50
    v_lshlrev_b32 v16, 16, v56
    v_and_b32 v17, s33, v56
    v_lshlrev_b32 v18, 16, v57
    v_and_b32 v19, s33, v57
    v_pk_mul_f32 v[16:17], v[16:17], v[8:9]
    v_pk_mul_f32 v[18:19], v[18:19], v[10:11]
    v_cvt_pk_bf16_f32 v56, v16, v17
    v_cvt_pk_bf16_f32 v57, v18, v19
    v_lshlrev_b32 v20, 16, v58
    v_and_b32 v21, s33, v58
    v_lshlrev_b32 v22, 16, v59
    v_and_b32 v23, s33, v59
    v_pk_mul_f32 v[20:21], v[20:21], v[12:13]
    v_pk_mul_f32 v[22:23], v[22:23], v[14:15]
    v_cvt_pk_bf16_f32 v58, v20, v21
    v_cvt_pk_bf16_f32 v59, v22, v23
    buffer_store_dwordx4 v[56:59], v2, s[8:11], s31 offen sc1
    s_bfe_u32 s31, s54, 0x40014
    s_mul_i32 s31, s31, s49
    s_add_u32 s31, s31, s50
    v_lshlrev_b32 v16, 16, v60
    v_and_b32 v17, s33, v60
    v_lshlrev_b32 v18, 16, v61
    v_and_b32 v19, s33, v61
    v_pk_mul_f32 v[16:17], v[16:17], v[8:9]
    v_pk_mul_f32 v[18:19], v[18:19], v[10:11]
    v_cvt_pk_bf16_f32 v60, v16, v17
    v_cvt_pk_bf16_f32 v61, v18, v19
    v_lshlrev_b32 v20, 16, v62
    v_and_b32 v21, s33, v62
    v_lshlrev_b32 v22, 16, v63
    v_and_b32 v23, s33, v63
    v_pk_mul_f32 v[20:21], v[20:21], v[12:13]
    v_pk_mul_f32 v[22:23], v[22:23], v[14:15]
    v_cvt_pk_bf16_f32 v62, v20, v21
    v_cvt_pk_bf16_f32 v63, v22, v23
    buffer_store_dwordx4 v[60:63], v2, s[8:11], s31 offen sc1
    s_bfe_u32 s31, s57, 0x40010
    s_mul_i32 s31, s31, s49
    s_add_u32 s31, s31, s53
    v_lshlrev_b32 v16, 16, v152
    v_and_b32 v17, s33, v152
    v_lshlrev_b32 v18, 16, v153
    v_and_b32 v19, s33, v153
    v_pk_mul_f32 v[16:17], v[16:17], v[8:9]
    v_pk_mul_f32 v[18:19], v[18:19], v[10:11]
    v_cvt_pk_bf16_f32 v152, v16, v17
    v_cvt_pk_bf16_f32 v153, v18, v19
    v_lshlrev_b32 v20, 16, v154
    v_and_b32 v21, s33, v154
    v_lshlrev_b32 v22, 16, v155
    v_and_b32 v23, s33, v155
    v_pk_mul_f32 v[20:21], v[20:21], v[12:13]
    v_pk_mul_f32 v[22:23], v[22:23], v[14:15]
    v_cvt_pk_bf16_f32 v154, v20, v21
    v_cvt_pk_bf16_f32 v155, v22, v23
    buffer_store_dwordx4 v[152:155], v2, s[8:11], s31 offen sc1
    s_bfe_u32 s31, s57, 0x40014
    s_mul_i32 s31, s31, s49
    s_add_u32 s31, s31, s53
    v_lshlrev_b32 v16, 16, v156
    v_and_b32 v17, s33, v156
    v_lshlrev_b32 v18, 16, v157
    v_and_b32 v19, s33, v157
    v_pk_mul_f32 v[16:17], v[16:17], v[8:9]
    v_pk_mul_f32 v[18:19], v[18:19], v[10:11]
    v_cvt_pk_bf16_f32 v156, v16, v17
    v_cvt_pk_bf16_f32 v157, v18, v19
    v_lshlrev_b32 v20, 16, v158
    v_and_b32 v21, s33, v158
    v_lshlrev_b32 v22, 16, v159
    v_and_b32 v23, s33, v159
    v_pk_mul_f32 v[20:21], v[20:21], v[12:13]
    v_pk_mul_f32 v[22:23], v[22:23], v[14:15]
    v_cvt_pk_bf16_f32 v158, v20, v21
    v_cvt_pk_bf16_f32 v159, v22, v23
    buffer_store_dwordx4 v[156:159], v2, s[8:11], s31 offen sc1
    s_bfe_u32 s31, s55, 0x40010
    s_mul_i32 s31, s31, s49
    s_add_u32 s31, s31, s51
    v_lshlrev_b32 v16, 16, v88
    v_and_b32 v17, s33, v88
    v_lshlrev_b32 v18, 16, v89
    v_and_b32 v19, s33, v89
    v_pk_mul_f32 v[16:17], v[16:17], v[8:9]
    v_pk_mul_f32 v[18:19], v[18:19], v[10:11]
    v_cvt_pk_bf16_f32 v88, v16, v17
    v_cvt_pk_bf16_f32 v89, v18, v19
    v_lshlrev_b32 v20, 16, v90
    v_and_b32 v21, s33, v90
    v_lshlrev_b32 v22, 16, v91
    v_and_b32 v23, s33, v91
    v_pk_mul_f32 v[20:21], v[20:21], v[12:13]
    v_pk_mul_f32 v[22:23], v[22:23], v[14:15]
    v_cvt_pk_bf16_f32 v90, v20, v21
    v_cvt_pk_bf16_f32 v91, v22, v23
    buffer_store_dwordx4 v[88:91], v2, s[8:11], s31 offen sc1
    s_bfe_u32 s31, s55, 0x40014
    s_mul_i32 s31, s31, s49
    s_add_u32 s31, s31, s51
    v_lshlrev_b32 v16, 16, v92
    v_and_b32 v17, s33, v92
    v_lshlrev_b32 v18, 16, v93
    v_and_b32 v19, s33, v93
    v_pk_mul_f32 v[16:17], v[16:17], v[8:9]
    v_pk_mul_f32 v[18:19], v[18:19], v[10:11]
    v_cvt_pk_bf16_f32 v92, v16, v17
    v_cvt_pk_bf16_f32 v93, v18, v19
    v_lshlrev_b32 v20, 16, v94
    v_and_b32 v21, s33, v94
    v_lshlrev_b32 v22, 16, v95
    v_and_b32 v23, s33, v95
    v_pk_mul_f32 v[20:21], v[20:21], v[12:13]
    v_pk_mul_f32 v[22:23], v[22:23], v[14:15]
    v_cvt_pk_bf16_f32 v94, v20, v21
    v_cvt_pk_bf16_f32 v95, v22, v23
    buffer_store_dwordx4 v[92:95], v2, s[8:11], s31 offen sc1
    s_bfe_u32 s31, s56, 0x40018
    s_mul_i32 s31, s31, s49
    s_add_u32 s31, s31, s52
    v_lshlrev_b32 v16, 16, v128
    v_and_b32 v17, s33, v128
    v_lshlrev_b32 v18, 16, v129
    v_and_b32 v19, s33, v129
    v_pk_mul_f32 v[16:17], v[16:17], v[8:9]
    v_pk_mul_f32 v[18:19], v[18:19], v[10:11]
    v_cvt_pk_bf16_f32 v128, v16, v17
    v_cvt_pk_bf16_f32 v129, v18, v19
    v_lshlrev_b32 v20, 16, v130
    v_and_b32 v21, s33, v130
    v_lshlrev_b32 v22, 16, v131
    v_and_b32 v23, s33, v131
    v_pk_mul_f32 v[20:21], v[20:21], v[12:13]
    v_pk_mul_f32 v[22:23], v[22:23], v[14:15]
    v_cvt_pk_bf16_f32 v130, v20, v21
    v_cvt_pk_bf16_f32 v131, v22, v23
    buffer_store_dwordx4 v[128:131], v2, s[8:11], s31 offen sc1
    s_bfe_u32 s31, s56, 0x4001c
    s_mul_i32 s31, s31, s49
    s_add_u32 s31, s31, s52
    v_lshlrev_b32 v16, 16, v132
    v_and_b32 v17, s33, v132
    v_lshlrev_b32 v18, 16, v133
    v_and_b32 v19, s33, v133
    v_pk_mul_f32 v[16:17], v[16:17], v[8:9]
    v_pk_mul_f32 v[18:19], v[18:19], v[10:11]
    v_cvt_pk_bf16_f32 v132, v16, v17
    v_cvt_pk_bf16_f32 v133, v18, v19
    v_lshlrev_b32 v20, 16, v134
    v_and_b32 v21, s33, v134
    v_lshlrev_b32 v22, 16, v135
    v_and_b32 v23, s33, v135
    v_pk_mul_f32 v[20:21], v[20:21], v[12:13]
    v_pk_mul_f32 v[22:23], v[22:23], v[14:15]
    v_cvt_pk_bf16_f32 v134, v20, v21
    v_cvt_pk_bf16_f32 v135, v22, v23
    buffer_store_dwordx4 v[132:135], v2, s[8:11], s31 offen sc1
    s_bfe_u32 s31, s54, 0x40018
    s_mul_i32 s31, s31, s49
    s_add_u32 s31, s31, s50
    v_lshlrev_b32 v16, 16, v64
    v_and_b32 v17, s33, v64
    v_lshlrev_b32 v18, 16, v65
    v_and_b32 v19, s33, v65
    v_pk_mul_f32 v[16:17], v[16:17], v[8:9]
    v_pk_mul_f32 v[18:19], v[18:19], v[10:11]
    v_cvt_pk_bf16_f32 v64, v16, v17
    v_cvt_pk_bf16_f32 v65, v18, v19
    v_lshlrev_b32 v20, 16, v66
    v_and_b32 v21, s33, v66
    v_lshlrev_b32 v22, 16, v67
    v_and_b32 v23, s33, v67
    v_pk_mul_f32 v[20:21], v[20:21], v[12:13]
    v_pk_mul_f32 v[22:23], v[22:23], v[14:15]
    v_cvt_pk_bf16_f32 v66, v20, v21
    v_cvt_pk_bf16_f32 v67, v22, v23
    buffer_store_dwordx4 v[64:67], v2, s[8:11], s31 offen sc1
    s_bfe_u32 s31, s54, 0x4001c
    s_mul_i32 s31, s31, s49
    s_add_u32 s31, s31, s50
    v_lshlrev_b32 v16, 16, v68
    v_and_b32 v17, s33, v68
    v_lshlrev_b32 v18, 16, v69
    v_and_b32 v19, s33, v69
    v_pk_mul_f32 v[16:17], v[16:17], v[8:9]
    v_pk_mul_f32 v[18:19], v[18:19], v[10:11]
    v_cvt_pk_bf16_f32 v68, v16, v17
    v_cvt_pk_bf16_f32 v69, v18, v19
    v_lshlrev_b32 v20, 16, v70
    v_and_b32 v21, s33, v70
    v_lshlrev_b32 v22, 16, v71
    v_and_b32 v23, s33, v71
    v_pk_mul_f32 v[20:21], v[20:21], v[12:13]
    v_pk_mul_f32 v[22:23], v[22:23], v[14:15]
    v_cvt_pk_bf16_f32 v70, v20, v21
    v_cvt_pk_bf16_f32 v71, v22, v23
    buffer_store_dwordx4 v[68:71], v2, s[8:11], s31 offen sc1
    s_bfe_u32 s31, s57, 0x40018
    s_mul_i32 s31, s31, s49
    s_add_u32 s31, s31, s53
    v_lshlrev_b32 v16, 16, v160
    v_and_b32 v17, s33, v160
    v_lshlrev_b32 v18, 16, v161
    v_and_b32 v19, s33, v161
    v_pk_mul_f32 v[16:17], v[16:17], v[8:9]
    v_pk_mul_f32 v[18:19], v[18:19], v[10:11]
    v_cvt_pk_bf16_f32 v160, v16, v17
    v_cvt_pk_bf16_f32 v161, v18, v19
    v_lshlrev_b32 v20, 16, v162
    v_and_b32 v21, s33, v162
    v_lshlrev_b32 v22, 16, v163
    v_and_b32 v23, s33, v163
    v_pk_mul_f32 v[20:21], v[20:21], v[12:13]
    v_pk_mul_f32 v[22:23], v[22:23], v[14:15]
    v_cvt_pk_bf16_f32 v162, v20, v21
    v_cvt_pk_bf16_f32 v163, v22, v23
    buffer_store_dwordx4 v[160:163], v2, s[8:11], s31 offen sc1
    s_bfe_u32 s31, s57, 0x4001c
    s_mul_i32 s31, s31, s49
    s_add_u32 s31, s31, s53
    v_lshlrev_b32 v16, 16, v164
    v_and_b32 v17, s33, v164
    v_lshlrev_b32 v18, 16, v165
    v_and_b32 v19, s33, v165
    v_pk_mul_f32 v[16:17], v[16:17], v[8:9]
    v_pk_mul_f32 v[18:19], v[18:19], v[10:11]
    v_cvt_pk_bf16_f32 v164, v16, v17
    v_cvt_pk_bf16_f32 v165, v18, v19
    v_lshlrev_b32 v20, 16, v166
    v_and_b32 v21, s33, v166
    v_lshlrev_b32 v22, 16, v167
    v_and_b32 v23, s33, v167
    v_pk_mul_f32 v[20:21], v[20:21], v[12:13]
    v_pk_mul_f32 v[22:23], v[22:23], v[14:15]
    v_cvt_pk_bf16_f32 v166, v20, v21
    v_cvt_pk_bf16_f32 v167, v22, v23
    buffer_store_dwordx4 v[164:167], v2, s[8:11], s31 offen sc1
    s_bfe_u32 s31, s55, 0x40018
    s_mul_i32 s31, s31, s49
    s_add_u32 s31, s31, s51
    v_lshlrev_b32 v16, 16, v96
    v_and_b32 v17, s33, v96
    v_lshlrev_b32 v18, 16, v97
    v_and_b32 v19, s33, v97
    v_pk_mul_f32 v[16:17], v[16:17], v[8:9]
    v_pk_mul_f32 v[18:19], v[18:19], v[10:11]
    v_cvt_pk_bf16_f32 v96, v16, v17
    v_cvt_pk_bf16_f32 v97, v18, v19
    v_lshlrev_b32 v20, 16, v98
    v_and_b32 v21, s33, v98
    v_lshlrev_b32 v22, 16, v99
    v_and_b32 v23, s33, v99
    v_pk_mul_f32 v[20:21], v[20:21], v[12:13]
    v_pk_mul_f32 v[22:23], v[22:23], v[14:15]
    v_cvt_pk_bf16_f32 v98, v20, v21
    v_cvt_pk_bf16_f32 v99, v22, v23
    buffer_store_dwordx4 v[96:99], v2, s[8:11], s31 offen sc1
    s_bfe_u32 s31, s55, 0x4001c
    s_mul_i32 s31, s31, s49
    s_add_u32 s31, s31, s51
    v_lshlrev_b32 v16, 16, v100
    v_and_b32 v17, s33, v100
    v_lshlrev_b32 v18, 16, v101
    v_and_b32 v19, s33, v101
    v_pk_mul_f32 v[16:17], v[16:17], v[8:9]
    v_pk_mul_f32 v[18:19], v[18:19], v[10:11]
    v_cvt_pk_bf16_f32 v100, v16, v17
    v_cvt_pk_bf16_f32 v101, v18, v19
    v_lshlrev_b32 v20, 16, v102
    v_and_b32 v21, s33, v102
    v_lshlrev_b32 v22, 16, v103
    v_and_b32 v23, s33, v103
    v_pk_mul_f32 v[20:21], v[20:21], v[12:13]
    v_pk_mul_f32 v[22:23], v[22:23], v[14:15]
    v_cvt_pk_bf16_f32 v102, v20, v21
    v_cvt_pk_bf16_f32 v103, v22, v23
    buffer_store_dwordx4 v[100:103], v2, s[8:11], s31 offen sc1
L_stored:
L_end:
    s_endpgm
L_clear:
    v_mov_b32 v16, -1
    v_mov_b32 v17, -1
    v_mov_b32 v18, -1
    v_mov_b32 v19, -1
    s_mov_b32 s38, 0
    buffer_store_dwordx4 v[16:19], v0, s[12:15], s38 offen sc1
    s_mov_b32 s38, 2048
    buffer_store_dwordx4 v[16:19], v0, s[12:15], s38 offen sc1
    s_mov_b32 s38, 4096
    buffer_store_dwordx4 v[16:19], v0, s[12:15], s38 offen sc1
    s_mov_b32 s38, 6144
    buffer_store_dwordx4 v[16:19], v0, s[12:15], s38 offen sc1
    s_mov_b32 s38, 8192
    buffer_store_dwordx4 v[16:19], v0, s[12:15], s38 offen sc1
    s_mov_b32 s38, 10240
    buffer_store_dwordx4 v[16:19], v0, s[12:15], s38 offen sc1
    s_mov_b32 s38, 12288
    buffer_store_dwordx4 v[16:19], v0, s[12:15], s38 offen sc1
    s_mov_b32 s38, 14336
    buffer_store_dwordx4 v[16:19], v0, s[12:15], s38 offen sc1
    s_mov_b32 s38, 16384
    buffer_store_dwordx4 v[16:19], v0, s[12:15], s38 offen sc1
    s_mov_b32 s38, 18432
    buffer_store_dwordx4 v[16:19], v0, s[12:15], s38 offen sc1
    s_mov_b32 s38, 20480
    buffer_store_dwordx4 v[16:19], v0, s[12:15], s38 offen sc1
    s_mov_b32 s38, 22528
    buffer_store_dwordx4 v[16:19], v0, s[12:15], s38 offen sc1
    s_mov_b32 s38, 24576
    buffer_store_dwordx4 v[16:19], v0, s[12:15], s38 offen sc1
    s_mov_b32 s38, 26624
    buffer_store_dwordx4 v[16:19], v0, s[12:15], s38 offen sc1
    s_mov_b32 s38, 28672
    buffer_store_dwordx4 v[16:19], v0, s[12:15], s38 offen sc1
    s_mov_b32 s38, 30720
    buffer_store_dwordx4 v[16:19], v0, s[12:15], s38 offen sc1
    s_branch L_cleared
.section .rodata,"a"
.p2align 6
.amdhsa_kernel standalone__se_block__vision_kernel
  .amdhsa_next_free_vgpr 168
  .amdhsa_next_free_sgpr 64
  .amdhsa_accum_offset 168
  .amdhsa_group_segment_fixed_size 0
  .amdhsa_kernarg_size 48
  .amdhsa_user_sgpr_count 2
  .amdhsa_user_sgpr_kernarg_segment_ptr 1
  .amdhsa_system_sgpr_workgroup_id_x 1
  .amdhsa_float_denorm_mode_32 3
.end_amdhsa_kernel
```
